```python
import torch

def _softmax(x, axis=-1):
    return torch.softmax(x, dim=axis)
def _gelu(x):
    return torch.nn.functional.gelu(x, approximate="tanh")
def _silu(x):
    return torch.nn.functional.silu(x)
def _sigmoid(x):
    return torch.sigmoid(x)
def _layernorm(x, axis=-1, eps=1e-5):
    m = x.mean(dim=axis, keepdim=True)
    v = x.var(dim=axis, keepdim=True, unbiased=False)
    return (x - m) / torch.sqrt(v + eps)
def _scatter_add(tgt, idx, src, axis=0):
    return tgt.clone().index_add_(axis, idx, src)
def _segment_sum(src, seg, n):
    out = torch.zeros((n,) + src.shape[1:], dtype=src.dtype)
    return out.index_add_(0, seg, src)
def _pad(x, pw):
    flat = tuple(v for pair in reversed(pw) for v in pair)
    return torch.nn.functional.pad(x, flat)

kernel_name = 'standalone__geglu_ffn__sampling'

def setup_inputs():

    _w = (lambda a: (lambda t: t.to(torch.bfloat16) if t.is_floating_point() else t)(torch.as_tensor(a)))
    B, S, D, F = 32, 32, 1024, 3584
    return {
        "x": _w((lambda *s: torch.randn(*s, dtype=torch.bfloat16) * 0.05)(B, S, D)),
        "w_gate": _w((lambda *s: torch.randn(*s, dtype=torch.bfloat16) * 0.05)(D, F)),
        "w_up": _w((lambda *s: torch.randn(*s, dtype=torch.bfloat16) * 0.05)(D, F)),
        "w_down": _w((lambda *s: torch.randn(*s, dtype=torch.bfloat16) * 0.05)(F, D)),
    }

def reference(x, w_gate, w_up, w_down):
    return (_gelu(x @ w_gate) * (x @ w_up)) @ w_down
```

```asm
; @launch grid=(256,1,1) block=(512,1,1) lds=163840
    .amdgcn_target "amdgcn-amd-amdhsa--gfx950"
    .text
    .globl standalone__geglu_ffn__sampling_kernel
    .p2align 8
    .type standalone__geglu_ffn__sampling_kernel,@function
standalone__geglu_ffn__sampling_kernel:
    s_load_dwordx8 s[4:11], s[0:1], 0
    s_load_dwordx4 s[44:47], s[0:1], 32
    s_load_dwordx2 s[48:49], s[0:1], 48
    v_lshrrev_b32 v16, 6, v0
    v_and_b32 v0, 63, v0
    s_and_b32 s28, s2, 7
    s_lshr_b32 s29, s2, 3
    s_and_b32 s30, s29, 3
    s_lshr_b32 s31, s29, 2
    v_readfirstlane_b32 s3, v16
    s_cmp_ge_u32 s2, 224
    s_cbranch_scc1 L_IDLE
    s_mul_i32 s32, s28, 7
    s_add_u32 s31, s31, s32
    s_cmp_lt_u32 s3, 4
    s_cbranch_scc1 L_COMPUTE
    s_sub_u32 s43, s3, 4
    v_lshrrev_b32 v26, 3, v0
    v_and_b32 v27, 7, v0
    v_lshrrev_b32 v28, 4, v0
    v_and_b32 v29, 1, v28
    v_lshlrev_b32 v29, 1, v29
    v_xor_b32 v29, v27, v29
    v_lshlrev_b32 v29, 4, v29
    s_movk_i32 s33, 7168
    v_mul_lo_u32 v30, v26, s33
    v_add_u32 v29, v29, v30
    s_mul_i32 s33, s43, 114688
    s_lshl_b32 s34, s31, 7
    s_add_u32 s33, s33, s34
    v_add_u32 v24, s33, v29
    v_xor_b32 v25, 64, v24
    v_add_u32 v25, 56320, v25
    v_xor_b32 v29, v27, v28
    v_lshlrev_b32 v29, 4, v29
    v_lshl_add_u32 v29, v26, 11, v29
    s_lshl_b32 s32, s30, 2
    s_add_u32 s32, s32, s43
    s_lshl_b32 s32, s32, 17
    v_add_u32 v16, s32, v29
    v_xor_b32 v17, 64, v16
    v_add_u32 v17, 15360, v17
    v_add_u32 v18, 30720, v16
    v_add_u32 v19, 30720, v17
    v_add_u32 v20, 0x10000, v16
    v_add_u32 v21, 0x10000, v17
    v_add_u32 v22, 0x10000, v18
    v_add_u32 v23, 0x10000, v19
    s_lshl_b32 s36, s43, 13
    s_lshl_b32 s37, s43, 11
    s_add_u32 s37, s37, 0x8000
    s_mov_b32 s38, 0
    s_mov_b32 s39, 0
    s_mov_b32 s35, 0
    s_mov_b32 s42, 0
    s_mov_b32 s14, 2097152
    s_mov_b32 s15, 0x20000
    s_mov_b32 s18, 7340032
    s_mov_b32 s19, 0x20000
    s_mov_b32 s22, 7340032
    s_mov_b32 s23, 0x20000
    s_waitcnt lgkmcnt(0)
    s_mov_b64 s[12:13], s[4:5]
    s_mov_b64 s[16:17], s[6:7]
    s_mov_b64 s[20:21], s[8:9]
    s_add_u32 m0, s35, s37
    s_add_u32 s41, s35, s36
    buffer_load_dwordx4 v24, s[16:19], s39 offen offset:0 nt lds
    buffer_load_dwordx4 v25, s[16:19], s39 offen offset:1024 nt lds
    s_add_u32 m0, m0, 8192
    s_nop 0
    buffer_load_dwordx4 v24, s[20:23], s39 offen offset:0 nt lds
    buffer_load_dwordx4 v25, s[20:23], s39 offen offset:1024 nt lds
    s_add_u32 m0, s41, 0
    s_nop 0
    buffer_load_dwordx4 v16, s[12:15], s38 offen offset:0 lds
    buffer_load_dwordx4 v17, s[12:15], s38 offen offset:1024 lds
    buffer_load_dwordx4 v18, s[12:15], s38 offen offset:2048 lds
    buffer_load_dwordx4 v19, s[12:15], s38 offen offset:3072 lds
    s_add_u32 m0, s41, 4096
    s_nop 0
    buffer_load_dwordx4 v20, s[12:15], s38 offen offset:0 lds
    buffer_load_dwordx4 v21, s[12:15], s38 offen offset:1024 lds
    buffer_load_dwordx4 v22, s[12:15], s38 offen offset:2048 lds
    buffer_load_dwordx4 v23, s[12:15], s38 offen offset:3072 lds
    s_add_u32 s39, s39, 458752
    s_add_u32 s38, s38, 128
    s_sub_u32 s35, s35, 49152
    s_cselect_b32 s35, 98304, s35
    s_add_u32 m0, s35, s37
    s_add_u32 s41, s35, s36
    buffer_load_dwordx4 v24, s[16:19], s39 offen offset:0 nt lds
    buffer_load_dwordx4 v25, s[16:19], s39 offen offset:1024 nt lds
    s_add_u32 m0, m0, 8192
    s_nop 0
    buffer_load_dwordx4 v24, s[20:23], s39 offen offset:0 nt lds
    buffer_load_dwordx4 v25, s[20:23], s39 offen offset:1024 nt lds
    s_add_u32 m0, s41, 0
    s_nop 0
    buffer_load_dwordx4 v16, s[12:15], s38 offen offset:0 lds
    buffer_load_dwordx4 v17, s[12:15], s38 offen offset:1024 lds
    buffer_load_dwordx4 v18, s[12:15], s38 offen offset:2048 lds
    buffer_load_dwordx4 v19, s[12:15], s38 offen offset:3072 lds
    s_add_u32 m0, s41, 4096
    s_nop 0
    buffer_load_dwordx4 v20, s[12:15], s38 offen offset:0 lds
    buffer_load_dwordx4 v21, s[12:15], s38 offen offset:1024 lds
    buffer_load_dwordx4 v22, s[12:15], s38 offen offset:2048 lds
    buffer_load_dwordx4 v23, s[12:15], s38 offen offset:3072 lds
    s_add_u32 s39, s39, 458752
    s_mov_b32 s42, 2
    s_lshr_b32 s50, s28, 2
    s_lshl_b32 s50, s50, 3
    s_and_b32 s75, s29, 7
    s_add_u32 s50, s50, s75
    s_and_b32 s51, s28, 3
    s_lshl_b32 s51, s51, 2
    s_lshr_b32 s79, s29, 3
    s_add_u32 s51, s51, s79
    s_xor_b32 s75, s3, 4
    s_mul_i32 s75, s75, 14
    s_lshl_b32 s68, s51, 7
    s_lshl_b32 s70, s75, 16
    s_add_u32 s68, s68, s70
    s_add_u32 s70, s68, 3670016
    s_mul_i32 s72, s50, 458752
    s_mul_i32 s75, s75, 4096
    s_add_u32 s72, s72, s75
    s_and_b32 s74, s3, 3
    s_lshl_b32 s74, s74, 12
    s_lshr_b32 s75, s3, 2
    s_mul_i32 s75, s75, 81920
    s_add_u32 s74, s74, s75
    s_mov_b32 s52, s10
    s_mov_b32 s53, s11
    s_mov_b32 s54, 7340032
    s_mov_b32 s55, 0x20000
    s_mov_b32 s24, s48
    s_mov_b32 s25, s49
    s_mov_b32 s26, 7340032
    s_mov_b32 s27, 0x20000
    s_mov_b32 s56, s44
    s_mov_b32 s57, s45
    s_mov_b32 s58, 2097152
    s_mov_b32 s59, 0x20000
    s_mov_b32 s64, s46
    s_mov_b32 s65, s47
    s_mov_b32 s66, 256
    s_mov_b32 s67, 0x20000
    s_add_u32 s60, s48, 8388608
    s_addc_u32 s61, s49, 0
    s_mov_b32 s62, 8192
    s_mov_b32 s63, 0x20000
    v_lshlrev_b32 v1, 4, v0
    v_lshrrev_b32 v26, 3, v0
    v_and_b32 v27, 7, v0
    v_lshrrev_b32 v28, 4, v0
    v_lshlrev_b32 v28, 1, v28
    v_xor_b32 v27, v27, v28
    v_lshlrev_b32 v27, 4, v27
    v_lshl_add_u32 v2, v26, 11, v27
    v_add_u32 v3, 15360, v2
    v_add_u32 v4, 30720, v2
    v_add_u32 v5, 46080, v2
    v_and_b32 v26, 15, v0
    v_lshrrev_b32 v27, 4, v0
    v_lshrrev_b32 v28, 2, v26
    v_and_b32 v26, 3, v26
    v_lshrrev_b32 v29, 1, v28
    v_lshl_add_u32 v29, v27, 1, v29
    v_and_b32 v29, 3, v29
    v_lshlrev_b32 v29, 5, v29
    v_lshl_add_u32 v29, v26, 3, v29
    v_lshl_add_u32 v29, v28, 7, v29
    v_lshl_add_u32 v29, v27, 9, v29
    v_add_u32 v6, s74, v29
    v_xor_b32 v7, 32, v6
    v_xor_b32 v8, 64, v6
    v_xor_b32 v9, 96, v6
    v_add_u32 v10, 0x10000, v6
    v_add_u32 v11, 0x10000, v7
    v_add_u32 v12, 0x10000, v8
    v_add_u32 v13, 0x10000, v9
L_LLOOP:
    s_waitcnt vmcnt(12)
    s_barrier
L_LIN:
    s_add_u32 s38, s38, 128
    s_sub_u32 s35, s35, 49152
    s_cselect_b32 s35, 98304, s35
    s_add_u32 m0, s35, s37
    s_add_u32 s41, s35, s36
    buffer_load_dwordx4 v24, s[16:19], s39 offen offset:0 nt lds
    buffer_load_dwordx4 v25, s[16:19], s39 offen offset:1024 nt lds
    s_add_u32 m0, m0, 8192
    s_nop 0
    buffer_load_dwordx4 v24, s[20:23], s39 offen offset:0 nt lds
    buffer_load_dwordx4 v25, s[20:23], s39 offen offset:1024 nt lds
    s_add_u32 m0, s41, 0
    s_nop 0
    buffer_load_dwordx4 v16, s[12:15], s38 offen offset:0 lds
    buffer_load_dwordx4 v17, s[12:15], s38 offen offset:1024 lds
    buffer_load_dwordx4 v18, s[12:15], s38 offen offset:2048 lds
    buffer_load_dwordx4 v19, s[12:15], s38 offen offset:3072 lds
    s_add_u32 m0, s41, 4096
    s_nop 0
    buffer_load_dwordx4 v20, s[12:15], s38 offen offset:0 lds
    buffer_load_dwordx4 v21, s[12:15], s38 offen offset:1024 lds
    buffer_load_dwordx4 v22, s[12:15], s38 offen offset:2048 lds
    buffer_load_dwordx4 v23, s[12:15], s38 offen offset:3072 lds
    s_add_u32 s39, s39, 458752
    s_add_u32 s42, s42, 1
    s_cmp_lt_u32 s42, 16
    s_cbranch_scc1 L_LLOOP
    s_waitcnt vmcnt(12)
    s_barrier
    buffer_load_dwordx2 v[14:15], off, s[64:67], 0 sc1
    s_add_u32 m0, s74, 16384
    s_nop 0
    buffer_load_dwordx4 v2, s[52:55], s68 offen offset:0 lds
    buffer_load_dwordx4 v3, s[52:55], s68 offen offset:1024 lds
    buffer_load_dwordx4 v4, s[52:55], s68 offen offset:2048 lds
    buffer_load_dwordx4 v5, s[52:55], s68 offen offset:3072 lds
    s_add_u32 s68, s68, 65536
    s_add_u32 m0, s74, 32768
    s_nop 0
    buffer_load_dwordx4 v2, s[52:55], s68 offen offset:0 lds
    buffer_load_dwordx4 v3, s[52:55], s68 offen offset:1024 lds
    buffer_load_dwordx4 v4, s[52:55], s68 offen offset:2048 lds
    buffer_load_dwordx4 v5, s[52:55], s68 offen offset:3072 lds
    s_add_u32 s68, s68, 65536
    s_waitcnt vmcnt(9)
    s_barrier
    s_add_u32 m0, s74, 49152
    s_nop 0
    buffer_load_dwordx4 v2, s[52:55], s68 offen offset:0 lds
    buffer_load_dwordx4 v3, s[52:55], s68 offen offset:1024 lds
    buffer_load_dwordx4 v4, s[52:55], s68 offen offset:2048 lds
    buffer_load_dwordx4 v5, s[52:55], s68 offen offset:3072 lds
    s_add_u32 s68, s68, 65536
    s_add_u32 m0, s74, 65536
    s_nop 0
    buffer_load_dwordx4 v2, s[52:55], s68 offen offset:0 lds
    buffer_load_dwordx4 v3, s[52:55], s68 offen offset:1024 lds
    buffer_load_dwordx4 v4, s[52:55], s68 offen offset:2048 lds
    buffer_load_dwordx4 v5, s[52:55], s68 offen offset:3072 lds
    s_add_u32 s68, s68, 65536
    s_waitcnt vmcnt(12)
    ds_read_b64_tr_b16 v[48:49], v6 offset:16384
    ds_read_b64_tr_b16 v[50:51], v6 offset:18432
    ds_read_b64_tr_b16 v[52:53], v7 offset:16384
    ds_read_b64_tr_b16 v[54:55], v7 offset:18432
    ds_read_b64_tr_b16 v[56:57], v8 offset:16384
    ds_read_b64_tr_b16 v[58:59], v8 offset:18432
    ds_read_b64_tr_b16 v[60:61], v9 offset:16384
    ds_read_b64_tr_b16 v[62:63], v9 offset:18432
    s_waitcnt lgkmcnt(0)
    s_add_u32 m0, s74, 16384
    s_nop 0
    buffer_load_dwordx4 v2, s[52:55], s68 offen offset:0 lds
    buffer_load_dwordx4 v3, s[52:55], s68 offen offset:1024 lds
    buffer_load_dwordx4 v4, s[52:55], s68 offen offset:2048 lds
    buffer_load_dwordx4 v5, s[52:55], s68 offen offset:3072 lds
    s_add_u32 s68, s68, 65536
    s_waitcnt vmcnt(12)
    ds_read_b64_tr_b16 v[64:65], v6 offset:32768
    ds_read_b64_tr_b16 v[66:67], v6 offset:34816
    ds_read_b64_tr_b16 v[68:69], v7 offset:32768
    ds_read_b64_tr_b16 v[70:71], v7 offset:34816
    ds_read_b64_tr_b16 v[72:73], v8 offset:32768
    ds_read_b64_tr_b16 v[74:75], v8 offset:34816
    ds_read_b64_tr_b16 v[76:77], v9 offset:32768
    ds_read_b64_tr_b16 v[78:79], v9 offset:34816
    s_waitcnt lgkmcnt(0)
    s_add_u32 m0, s74, 32768
    s_nop 0
    buffer_load_dwordx4 v2, s[52:55], s68 offen offset:0 lds
    buffer_load_dwordx4 v3, s[52:55], s68 offen offset:1024 lds
    buffer_load_dwordx4 v4, s[52:55], s68 offen offset:2048 lds
    buffer_load_dwordx4 v5, s[52:55], s68 offen offset:3072 lds
    s_add_u32 s68, s68, 65536
    s_waitcnt vmcnt(12)
    ds_read_b64_tr_b16 v[80:81], v6 offset:49152
    ds_read_b64_tr_b16 v[82:83], v6 offset:51200
    ds_read_b64_tr_b16 v[84:85], v7 offset:49152
    ds_read_b64_tr_b16 v[86:87], v7 offset:51200
    ds_read_b64_tr_b16 v[88:89], v8 offset:49152
    ds_read_b64_tr_b16 v[90:91], v8 offset:51200
    ds_read_b64_tr_b16 v[92:93], v9 offset:49152
    ds_read_b64_tr_b16 v[94:95], v9 offset:51200
    s_waitcnt lgkmcnt(0)
    s_add_u32 m0, s74, 49152
    s_nop 0
    buffer_load_dwordx4 v2, s[52:55], s68 offen offset:0 lds
    buffer_load_dwordx4 v3, s[52:55], s68 offen offset:1024 lds
    buffer_load_dwordx4 v4, s[52:55], s68 offen offset:2048 lds
    buffer_load_dwordx4 v5, s[52:55], s68 offen offset:3072 lds
    s_add_u32 s68, s68, 65536
    s_waitcnt vmcnt(12)
    ds_read_b64_tr_b16 v[96:97], v10 offset:0
    ds_read_b64_tr_b16 v[98:99], v10 offset:2048
    ds_read_b64_tr_b16 v[100:101], v11 offset:0
    ds_read_b64_tr_b16 v[102:103], v11 offset:2048
    ds_read_b64_tr_b16 v[104:105], v12 offset:0
    ds_read_b64_tr_b16 v[106:107], v12 offset:2048
    ds_read_b64_tr_b16 v[108:109], v13 offset:0
    ds_read_b64_tr_b16 v[110:111], v13 offset:2048
    s_waitcnt lgkmcnt(0)
    s_add_u32 m0, s74, 65536
    s_nop 0
    buffer_load_dwordx4 v2, s[52:55], s68 offen offset:0 lds
    buffer_load_dwordx4 v3, s[52:55], s68 offen offset:1024 lds
    buffer_load_dwordx4 v4, s[52:55], s68 offen offset:2048 lds
    buffer_load_dwordx4 v5, s[52:55], s68 offen offset:3072 lds
    s_add_u32 s68, s68, 65536
    s_waitcnt vmcnt(12)
    ds_read_b64_tr_b16 v[112:113], v6 offset:16384
    ds_read_b64_tr_b16 v[114:115], v6 offset:18432
    ds_read_b64_tr_b16 v[116:117], v7 offset:16384
    ds_read_b64_tr_b16 v[118:119], v7 offset:18432
    ds_read_b64_tr_b16 v[120:121], v8 offset:16384
    ds_read_b64_tr_b16 v[122:123], v8 offset:18432
    ds_read_b64_tr_b16 v[124:125], v9 offset:16384
    ds_read_b64_tr_b16 v[126:127], v9 offset:18432
    s_waitcnt lgkmcnt(0)
    s_add_u32 m0, s74, 16384
    s_nop 0
    buffer_load_dwordx4 v2, s[52:55], s68 offen offset:0 lds
    buffer_load_dwordx4 v3, s[52:55], s68 offen offset:1024 lds
    buffer_load_dwordx4 v4, s[52:55], s68 offen offset:2048 lds
    buffer_load_dwordx4 v5, s[52:55], s68 offen offset:3072 lds
    s_add_u32 s68, s68, 65536
    s_waitcnt vmcnt(12)
    ds_read_b64_tr_b16 v[128:129], v6 offset:32768
    ds_read_b64_tr_b16 v[130:131], v6 offset:34816
    ds_read_b64_tr_b16 v[132:133], v7 offset:32768
    ds_read_b64_tr_b16 v[134:135], v7 offset:34816
    ds_read_b64_tr_b16 v[136:137], v8 offset:32768
    ds_read_b64_tr_b16 v[138:139], v8 offset:34816
    ds_read_b64_tr_b16 v[140:141], v9 offset:32768
    ds_read_b64_tr_b16 v[142:143], v9 offset:34816
    s_waitcnt lgkmcnt(0)
    s_add_u32 m0, s74, 32768
    s_nop 0
    buffer_load_dwordx4 v2, s[52:55], s68 offen offset:0 lds
    buffer_load_dwordx4 v3, s[52:55], s68 offen offset:1024 lds
    buffer_load_dwordx4 v4, s[52:55], s68 offen offset:2048 lds
    buffer_load_dwordx4 v5, s[52:55], s68 offen offset:3072 lds
    s_add_u32 s68, s68, 65536
    s_waitcnt vmcnt(12)
    ds_read_b64_tr_b16 v[144:145], v6 offset:49152
    ds_read_b64_tr_b16 v[146:147], v6 offset:51200
    ds_read_b64_tr_b16 v[148:149], v7 offset:49152
    ds_read_b64_tr_b16 v[150:151], v7 offset:51200
    ds_read_b64_tr_b16 v[152:153], v8 offset:49152
    ds_read_b64_tr_b16 v[154:155], v8 offset:51200
    ds_read_b64_tr_b16 v[156:157], v9 offset:49152
    ds_read_b64_tr_b16 v[158:159], v9 offset:51200
    s_waitcnt lgkmcnt(0)
    s_add_u32 m0, s74, 49152
    s_nop 0
    buffer_load_dwordx4 v2, s[52:55], s68 offen offset:0 lds
    buffer_load_dwordx4 v3, s[52:55], s68 offen offset:1024 lds
    buffer_load_dwordx4 v4, s[52:55], s68 offen offset:2048 lds
    buffer_load_dwordx4 v5, s[52:55], s68 offen offset:3072 lds
    s_add_u32 s68, s68, 65536
    s_waitcnt vmcnt(12)
    ds_read_b64_tr_b16 v[160:161], v10 offset:0
    ds_read_b64_tr_b16 v[162:163], v10 offset:2048
    ds_read_b64_tr_b16 v[164:165], v11 offset:0
    ds_read_b64_tr_b16 v[166:167], v11 offset:2048
    ds_read_b64_tr_b16 v[168:169], v12 offset:0
    ds_read_b64_tr_b16 v[170:171], v12 offset:2048
    ds_read_b64_tr_b16 v[172:173], v13 offset:0
    ds_read_b64_tr_b16 v[174:175], v13 offset:2048
    s_waitcnt lgkmcnt(0)
    s_add_u32 m0, s74, 65536
    s_nop 0
    buffer_load_dwordx4 v2, s[52:55], s68 offen offset:0 lds
    buffer_load_dwordx4 v3, s[52:55], s68 offen offset:1024 lds
    buffer_load_dwordx4 v4, s[52:55], s68 offen offset:2048 lds
    buffer_load_dwordx4 v5, s[52:55], s68 offen offset:3072 lds
    s_add_u32 s68, s68, 65536
    s_waitcnt vmcnt(12)
    ds_read_b64_tr_b16 v[176:177], v6 offset:16384
    ds_read_b64_tr_b16 v[178:179], v6 offset:18432
    ds_read_b64_tr_b16 v[180:181], v7 offset:16384
    ds_read_b64_tr_b16 v[182:183], v7 offset:18432
    ds_read_b64_tr_b16 v[184:185], v8 offset:16384
    ds_read_b64_tr_b16 v[186:187], v8 offset:18432
    ds_read_b64_tr_b16 v[188:189], v9 offset:16384
    ds_read_b64_tr_b16 v[190:191], v9 offset:18432
    s_waitcnt lgkmcnt(0)
    s_add_u32 m0, s74, 16384
    s_nop 0
    buffer_load_dwordx4 v2, s[52:55], s68 offen offset:0 lds
    buffer_load_dwordx4 v3, s[52:55], s68 offen offset:1024 lds
    buffer_load_dwordx4 v4, s[52:55], s68 offen offset:2048 lds
    buffer_load_dwordx4 v5, s[52:55], s68 offen offset:3072 lds
    s_add_u32 s68, s68, 65536
    s_barrier
    s_add_u32 m0, s74, 0
    s_nop 0
    buffer_load_dwordx4 v2, s[52:55], s68 offen offset:0 lds
    buffer_load_dwordx4 v3, s[52:55], s68 offen offset:1024 lds
    buffer_load_dwordx4 v4, s[52:55], s68 offen offset:2048 lds
    buffer_load_dwordx4 v5, s[52:55], s68 offen offset:3072 lds
    s_add_u32 s68, s68, 65536
    s_branch L_WDONE
L_IDLE:
    s_cmp_ge_u32 s2, 256
    s_cbranch_scc1 L_END
    s_waitcnt lgkmcnt(0)
    s_lshr_b32 s50, s28, 2
    s_lshl_b32 s50, s50, 3
    s_and_b32 s75, s29, 7
    s_add_u32 s50, s50, s75
    s_and_b32 s51, s28, 3
    s_lshl_b32 s51, s51, 2
    s_lshr_b32 s79, s29, 3
    s_add_u32 s51, s51, s79
    s_xor_b32 s75, s3, 4
    s_mul_i32 s75, s75, 14
    s_lshl_b32 s68, s51, 7
    s_lshl_b32 s70, s75, 16
    s_add_u32 s68, s68, s70
    s_add_u32 s70, s68, 3670016
    s_mul_i32 s72, s50, 458752
    s_mul_i32 s75, s75, 4096
    s_add_u32 s72, s72, s75
    s_and_b32 s74, s3, 3
    s_lshl_b32 s74, s74, 12
    s_lshr_b32 s75, s3, 2
    s_mul_i32 s75, s75, 81920
    s_add_u32 s74, s74, s75
    s_mov_b32 s52, s10
    s_mov_b32 s53, s11
    s_mov_b32 s54, 7340032
    s_mov_b32 s55, 0x20000
    s_mov_b32 s24, s48
    s_mov_b32 s25, s49
    s_mov_b32 s26, 7340032
    s_mov_b32 s27, 0x20000
    s_mov_b32 s56, s44
    s_mov_b32 s57, s45
    s_mov_b32 s58, 2097152
    s_mov_b32 s59, 0x20000
    s_mov_b32 s64, s46
    s_mov_b32 s65, s47
    s_mov_b32 s66, 256
    s_mov_b32 s67, 0x20000
    s_add_u32 s60, s48, 8388608
    s_addc_u32 s61, s49, 0
    s_mov_b32 s62, 8192
    s_mov_b32 s63, 0x20000
    v_lshlrev_b32 v1, 4, v0
    v_lshrrev_b32 v26, 3, v0
    v_and_b32 v27, 7, v0
    v_lshrrev_b32 v28, 4, v0
    v_lshlrev_b32 v28, 1, v28
    v_xor_b32 v27, v27, v28
    v_lshlrev_b32 v27, 4, v27
    v_lshl_add_u32 v2, v26, 11, v27
    v_add_u32 v3, 15360, v2
    v_add_u32 v4, 30720, v2
    v_add_u32 v5, 46080, v2
    v_and_b32 v26, 15, v0
    v_lshrrev_b32 v27, 4, v0
    v_lshrrev_b32 v28, 2, v26
    v_and_b32 v26, 3, v26
    v_lshrrev_b32 v29, 1, v28
    v_lshl_add_u32 v29, v27, 1, v29
    v_and_b32 v29, 3, v29
    v_lshlrev_b32 v29, 5, v29
    v_lshl_add_u32 v29, v26, 3, v29
    v_lshl_add_u32 v29, v28, 7, v29
    v_lshl_add_u32 v29, v27, 9, v29
    v_add_u32 v6, s74, v29
    v_xor_b32 v7, 32, v6
    v_xor_b32 v8, 64, v6
    v_xor_b32 v9, 96, v6
    v_add_u32 v10, 0x10000, v6
    v_add_u32 v11, 0x10000, v7
    v_add_u32 v12, 0x10000, v8
    v_add_u32 v13, 0x10000, v9
    s_cmp_lg_u32 s2, 224
    s_cbranch_scc1 L_NONONCE
    s_cmp_lg_u32 s3, 0
    s_cbranch_scc1 L_NONONCE
    s_memrealtime s[76:77]
    s_waitcnt lgkmcnt(0)
    s_or_b32 s77, s77, 0x80000000
    v_mov_b32 v14, s76
    v_mov_b32 v15, s77
    s_mov_b64 exec, 1
    buffer_store_dwordx2 v[14:15], off, s[64:67], 0 sc1
    s_waitcnt vmcnt(0)
    s_mov_b64 exec, -1
L_NONONCE:
    s_sub_u32 s32, s2, 224
    s_mov_b32 s12, s4
    s_mov_b32 s13, s5
    s_mov_b32 s14, 2097152
    s_mov_b32 s15, 0x20000
    s_lshl_b32 s33, s32, 3
    s_add_u32 s33, s33, s3
    s_lshl_b32 s33, s33, 13
    s_add_u32 s34, s33, 4096
    buffer_load_dwordx4 v[32:35], v1, s[12:15], s33 offen offset:0
    buffer_load_dwordx4 v[36:39], v1, s[12:15], s33 offen offset:1024
    buffer_load_dwordx4 v[40:43], v1, s[12:15], s33 offen offset:2048
    buffer_load_dwordx4 v[44:47], v1, s[12:15], s33 offen offset:3072
    buffer_load_dwordx4 v[48:51], v1, s[12:15], s34 offen offset:0
    buffer_load_dwordx4 v[52:55], v1, s[12:15], s34 offen offset:1024
    buffer_load_dwordx4 v[56:59], v1, s[12:15], s34 offen offset:2048
    buffer_load_dwordx4 v[60:63], v1, s[12:15], s34 offen offset:3072
    s_mov_b32 s16, s6
    s_mov_b32 s17, s7
    s_mov_b32 s18, 7340032
    s_mov_b32 s19, 0x20000
    s_mov_b32 s20, s8
    s_mov_b32 s21, s9
    s_mov_b32 s22, 7340032
    s_mov_b32 s23, 0x20000
    v_min_u32 v26, 55, v0
    v_lshlrev_b32 v26, 4, v26
    v_add_u32 v27, 7168, v26
    s_lshr_b32 s33, s32, 3
    s_lshl_b32 s33, s33, 3
    s_add_u32 s33, s33, s3
    s_mul_i32 s33, s33, 14336
    s_mul_i32 s34, s28, 896
    s_add_u32 s33, s33, s34
    s_add_u32 s33, s33, 4128768
    buffer_load_dwordx4 v[64:67], v26, s[16:19], s33 offen offset:0
    buffer_load_dwordx4 v[68:71], v27, s[16:19], s33 offen offset:0
    buffer_load_dwordx4 v[72:75], v26, s[20:23], s33 offen offset:0
    buffer_load_dwordx4 v[76:79], v27, s[20:23], s33 offen offset:0
    s_add_u32 s33, s33, 458752
    s_waitcnt vmcnt(8)
    buffer_load_dwordx4 v[80:83], v26, s[16:19], s33 offen offset:0
    buffer_load_dwordx4 v[84:87], v27, s[16:19], s33 offen offset:0
    buffer_load_dwordx4 v[88:91], v26, s[20:23], s33 offen offset:0
    buffer_load_dwordx4 v[92:95], v27, s[20:23], s33 offen offset:0
    s_add_u32 s33, s33, 458752
    s_waitcnt vmcnt(8)
    buffer_load_dwordx4 v[32:35], v26, s[16:19], s33 offen offset:0
    buffer_load_dwordx4 v[36:39], v27, s[16:19], s33 offen offset:0
    buffer_load_dwordx4 v[40:43], v26, s[20:23], s33 offen offset:0
    buffer_load_dwordx4 v[44:47], v27, s[20:23], s33 offen offset:0
    s_add_u32 s33, s33, 458752
    s_waitcnt vmcnt(8)
    buffer_load_dwordx4 v[48:51], v26, s[16:19], s33 offen offset:0
    buffer_load_dwordx4 v[52:55], v27, s[16:19], s33 offen offset:0
    buffer_load_dwordx4 v[56:59], v26, s[20:23], s33 offen offset:0
    buffer_load_dwordx4 v[60:63], v27, s[20:23], s33 offen offset:0
    s_add_u32 s33, s33, 458752
    s_waitcnt vmcnt(8)
    buffer_load_dwordx4 v[64:67], v26, s[16:19], s33 offen offset:0
    buffer_load_dwordx4 v[68:71], v27, s[16:19], s33 offen offset:0
    buffer_load_dwordx4 v[72:75], v26, s[20:23], s33 offen offset:0
    buffer_load_dwordx4 v[76:79], v27, s[20:23], s33 offen offset:0
    s_add_u32 s33, s33, 458752
    s_waitcnt vmcnt(8)
    buffer_load_dwordx4 v[80:83], v26, s[16:19], s33 offen offset:0
    buffer_load_dwordx4 v[84:87], v27, s[16:19], s33 offen offset:0
    buffer_load_dwordx4 v[88:91], v26, s[20:23], s33 offen offset:0
    buffer_load_dwordx4 v[92:95], v27, s[20:23], s33 offen offset:0
    s_add_u32 s33, s33, 458752
    s_waitcnt vmcnt(8)
    buffer_load_dwordx4 v[32:35], v26, s[16:19], s33 offen offset:0
    buffer_load_dwordx4 v[36:39], v27, s[16:19], s33 offen offset:0
    buffer_load_dwordx4 v[40:43], v26, s[20:23], s33 offen offset:0
    buffer_load_dwordx4 v[44:47], v27, s[20:23], s33 offen offset:0
    s_add_u32 s33, s33, 458752
    s_waitcnt vmcnt(8)
    s_and_b32 s33, s32, 1
    s_lshl_b32 s33, s33, 10
    s_lshr_b32 s32, s32, 1
    s_lshl_b32 s32, s32, 3
    s_add_u32 s32, s32, s3
    s_mul_i32 s32, s32, 57344
    s_add_u32 s33, s33, s32
    buffer_load_dwordx4 v[48:51], v1, s[52:55], s33 offen offset:0
    buffer_load_dwordx4 v[52:55], v1, s[52:55], s33 offen offset:2048
    s_add_u32 s33, s33, 4096
    buffer_load_dwordx4 v[56:59], v1, s[52:55], s33 offen offset:0
    buffer_load_dwordx4 v[60:63], v1, s[52:55], s33 offen offset:2048
    s_add_u32 s33, s33, 4096
    buffer_load_dwordx4 v[64:67], v1, s[52:55], s33 offen offset:0
    buffer_load_dwordx4 v[68:71], v1, s[52:55], s33 offen offset:2048
    s_add_u32 s33, s33, 4096
    buffer_load_dwordx4 v[72:75], v1, s[52:55], s33 offen offset:0
    buffer_load_dwordx4 v[76:79], v1, s[52:55], s33 offen offset:2048
    s_add_u32 s33, s33, 4096
    buffer_load_dwordx4 v[80:83], v1, s[52:55], s33 offen offset:0
    buffer_load_dwordx4 v[84:87], v1, s[52:55], s33 offen offset:2048
    s_add_u32 s33, s33, 4096
    buffer_load_dwordx4 v[88:91], v1, s[52:55], s33 offen offset:0
    buffer_load_dwordx4 v[92:95], v1, s[52:55], s33 offen offset:2048
    s_add_u32 s33, s33, 4096
    buffer_load_dwordx4 v[32:35], v1, s[52:55], s33 offen offset:0
    buffer_load_dwordx4 v[36:39], v1, s[52:55], s33 offen offset:2048
    s_add_u32 s33, s33, 4096
    buffer_load_dwordx4 v[40:43], v1, s[52:55], s33 offen offset:0
    buffer_load_dwordx4 v[44:47], v1, s[52:55], s33 offen offset:2048
    s_add_u32 s33, s33, 4096
    buffer_load_dwordx4 v[48:51], v1, s[52:55], s33 offen offset:0
    buffer_load_dwordx4 v[52:55], v1, s[52:55], s33 offen offset:2048
    s_add_u32 s33, s33, 4096
    buffer_load_dwordx4 v[56:59], v1, s[52:55], s33 offen offset:0
    buffer_load_dwordx4 v[60:63], v1, s[52:55], s33 offen offset:2048
    s_add_u32 s33, s33, 4096
    buffer_load_dwordx4 v[64:67], v1, s[52:55], s33 offen offset:0
    buffer_load_dwordx4 v[68:71], v1, s[52:55], s33 offen offset:2048
    s_add_u32 s33, s33, 4096
    buffer_load_dwordx4 v[72:75], v1, s[52:55], s33 offen offset:0
    buffer_load_dwordx4 v[76:79], v1, s[52:55], s33 offen offset:2048
    s_add_u32 s33, s33, 4096
    buffer_load_dwordx4 v[80:83], v1, s[52:55], s33 offen offset:0
    buffer_load_dwordx4 v[84:87], v1, s[52:55], s33 offen offset:2048
    s_add_u32 s33, s33, 4096
    buffer_load_dwordx4 v[88:91], v1, s[52:55], s33 offen offset:0
    buffer_load_dwordx4 v[92:95], v1, s[52:55], s33 offen offset:2048
    s_add_u32 s33, s33, 4096
    v_lshrrev_b32 v28, 1, v0
    v_and_b32 v29, 1, v0
    v_lshlrev_b32 v29, 6, v29
    v_lshl_add_u32 v28, v28, 11, v29
    s_sub_u32 s35, s29, 28
    s_lshl_b32 s35, s35, 3
    s_add_u32 s35, s35, s3
    s_mul_i32 s35, s35, 57344
    s_lshl_b32 s36, s51, 7
    s_add_u32 s35, s35, s36
    s_bfm_b64 exec, 56, 0
    buffer_load_dword v29, v28, s[52:55], s35 offen
    s_add_u32 s35, s35, 1835008
    buffer_load_dword v29, v28, s[52:55], s35 offen
    s_add_u32 s35, s35, 1835008
    buffer_load_dword v29, v28, s[52:55], s35 offen
    s_add_u32 s35, s35, 1835008
    buffer_load_dword v29, v28, s[52:55], s35 offen
    s_add_u32 s35, s35, 1835008
    s_mov_b64 exec, -1
    s_waitcnt vmcnt(0)
    buffer_load_dwordx2 v[14:15], off, s[64:67], 0 sc1
    s_cmp_lt_u32 s3, 4
    s_cbranch_scc1 L_IDLEB
    s_add_u32 m0, s74, 16384
    s_nop 0
    buffer_load_dwordx4 v2, s[52:55], s68 offen offset:0 lds
    buffer_load_dwordx4 v3, s[52:55], s68 offen offset:1024 lds
    buffer_load_dwordx4 v4, s[52:55], s68 offen offset:2048 lds
    buffer_load_dwordx4 v5, s[52:55], s68 offen offset:3072 lds
    s_add_u32 s68, s68, 65536
    s_add_u32 m0, s74, 32768
    s_nop 0
    buffer_load_dwordx4 v2, s[52:55], s68 offen offset:0 lds
    buffer_load_dwordx4 v3, s[52:55], s68 offen offset:1024 lds
    buffer_load_dwordx4 v4, s[52:55], s68 offen offset:2048 lds
    buffer_load_dwordx4 v5, s[52:55], s68 offen offset:3072 lds
    s_add_u32 s68, s68, 65536
    s_add_u32 m0, s74, 49152
    s_nop 0
    buffer_load_dwordx4 v2, s[52:55], s68 offen offset:0 lds
    buffer_load_dwordx4 v3, s[52:55], s68 offen offset:1024 lds
    buffer_load_dwordx4 v4, s[52:55], s68 offen offset:2048 lds
    buffer_load_dwordx4 v5, s[52:55], s68 offen offset:3072 lds
    s_add_u32 s68, s68, 65536
    s_add_u32 m0, s74, 65536
    s_nop 0
    buffer_load_dwordx4 v2, s[52:55], s68 offen offset:0 lds
    buffer_load_dwordx4 v3, s[52:55], s68 offen offset:1024 lds
    buffer_load_dwordx4 v4, s[52:55], s68 offen offset:2048 lds
    buffer_load_dwordx4 v5, s[52:55], s68 offen offset:3072 lds
    s_add_u32 s68, s68, 65536
    s_waitcnt vmcnt(12)
    ds_read_b64_tr_b16 v[48:49], v6 offset:16384
    ds_read_b64_tr_b16 v[50:51], v6 offset:18432
    ds_read_b64_tr_b16 v[52:53], v7 offset:16384
    ds_read_b64_tr_b16 v[54:55], v7 offset:18432
    ds_read_b64_tr_b16 v[56:57], v8 offset:16384
    ds_read_b64_tr_b16 v[58:59], v8 offset:18432
    ds_read_b64_tr_b16 v[60:61], v9 offset:16384
    ds_read_b64_tr_b16 v[62:63], v9 offset:18432
    s_waitcnt lgkmcnt(0)
    s_add_u32 m0, s74, 16384
    s_nop 0
    buffer_load_dwordx4 v2, s[52:55], s68 offen offset:0 lds
    buffer_load_dwordx4 v3, s[52:55], s68 offen offset:1024 lds
    buffer_load_dwordx4 v4, s[52:55], s68 offen offset:2048 lds
    buffer_load_dwordx4 v5, s[52:55], s68 offen offset:3072 lds
    s_add_u32 s68, s68, 65536
    s_waitcnt vmcnt(12)
    ds_read_b64_tr_b16 v[64:65], v6 offset:32768
    ds_read_b64_tr_b16 v[66:67], v6 offset:34816
    ds_read_b64_tr_b16 v[68:69], v7 offset:32768
    ds_read_b64_tr_b16 v[70:71], v7 offset:34816
    ds_read_b64_tr_b16 v[72:73], v8 offset:32768
    ds_read_b64_tr_b16 v[74:75], v8 offset:34816
    ds_read_b64_tr_b16 v[76:77], v9 offset:32768
    ds_read_b64_tr_b16 v[78:79], v9 offset:34816
    s_waitcnt lgkmcnt(0)
    s_add_u32 m0, s74, 32768
    s_nop 0
    buffer_load_dwordx4 v2, s[52:55], s68 offen offset:0 lds
    buffer_load_dwordx4 v3, s[52:55], s68 offen offset:1024 lds
    buffer_load_dwordx4 v4, s[52:55], s68 offen offset:2048 lds
    buffer_load_dwordx4 v5, s[52:55], s68 offen offset:3072 lds
    s_add_u32 s68, s68, 65536
    s_waitcnt vmcnt(12)
    ds_read_b64_tr_b16 v[80:81], v6 offset:49152
    ds_read_b64_tr_b16 v[82:83], v6 offset:51200
    ds_read_b64_tr_b16 v[84:85], v7 offset:49152
    ds_read_b64_tr_b16 v[86:87], v7 offset:51200
    ds_read_b64_tr_b16 v[88:89], v8 offset:49152
    ds_read_b64_tr_b16 v[90:91], v8 offset:51200
    ds_read_b64_tr_b16 v[92:93], v9 offset:49152
    ds_read_b64_tr_b16 v[94:95], v9 offset:51200
    s_waitcnt lgkmcnt(0)
    s_add_u32 m0, s74, 49152
    s_nop 0
    buffer_load_dwordx4 v2, s[52:55], s68 offen offset:0 lds
    buffer_load_dwordx4 v3, s[52:55], s68 offen offset:1024 lds
    buffer_load_dwordx4 v4, s[52:55], s68 offen offset:2048 lds
    buffer_load_dwordx4 v5, s[52:55], s68 offen offset:3072 lds
    s_add_u32 s68, s68, 65536
    s_waitcnt vmcnt(12)
    ds_read_b64_tr_b16 v[96:97], v10 offset:0
    ds_read_b64_tr_b16 v[98:99], v10 offset:2048
    ds_read_b64_tr_b16 v[100:101], v11 offset:0
    ds_read_b64_tr_b16 v[102:103], v11 offset:2048
    ds_read_b64_tr_b16 v[104:105], v12 offset:0
    ds_read_b64_tr_b16 v[106:107], v12 offset:2048
    ds_read_b64_tr_b16 v[108:109], v13 offset:0
    ds_read_b64_tr_b16 v[110:111], v13 offset:2048
    s_waitcnt lgkmcnt(0)
    s_add_u32 m0, s74, 65536
    s_nop 0
    buffer_load_dwordx4 v2, s[52:55], s68 offen offset:0 lds
    buffer_load_dwordx4 v3, s[52:55], s68 offen offset:1024 lds
    buffer_load_dwordx4 v4, s[52:55], s68 offen offset:2048 lds
    buffer_load_dwordx4 v5, s[52:55], s68 offen offset:3072 lds
    s_add_u32 s68, s68, 65536
    s_waitcnt vmcnt(12)
    ds_read_b64_tr_b16 v[112:113], v6 offset:16384
    ds_read_b64_tr_b16 v[114:115], v6 offset:18432
    ds_read_b64_tr_b16 v[116:117], v7 offset:16384
    ds_read_b64_tr_b16 v[118:119], v7 offset:18432
    ds_read_b64_tr_b16 v[120:121], v8 offset:16384
    ds_read_b64_tr_b16 v[122:123], v8 offset:18432
    ds_read_b64_tr_b16 v[124:125], v9 offset:16384
    ds_read_b64_tr_b16 v[126:127], v9 offset:18432
    s_waitcnt lgkmcnt(0)
    s_add_u32 m0, s74, 16384
    s_nop 0
    buffer_load_dwordx4 v2, s[52:55], s68 offen offset:0 lds
    buffer_load_dwordx4 v3, s[52:55], s68 offen offset:1024 lds
    buffer_load_dwordx4 v4, s[52:55], s68 offen offset:2048 lds
    buffer_load_dwordx4 v5, s[52:55], s68 offen offset:3072 lds
    s_add_u32 s68, s68, 65536
    s_waitcnt vmcnt(12)
    ds_read_b64_tr_b16 v[128:129], v6 offset:32768
    ds_read_b64_tr_b16 v[130:131], v6 offset:34816
    ds_read_b64_tr_b16 v[132:133], v7 offset:32768
    ds_read_b64_tr_b16 v[134:135], v7 offset:34816
    ds_read_b64_tr_b16 v[136:137], v8 offset:32768
    ds_read_b64_tr_b16 v[138:139], v8 offset:34816
    ds_read_b64_tr_b16 v[140:141], v9 offset:32768
    ds_read_b64_tr_b16 v[142:143], v9 offset:34816
    s_waitcnt lgkmcnt(0)
    s_add_u32 m0, s74, 32768
    s_nop 0
    buffer_load_dwordx4 v2, s[52:55], s68 offen offset:0 lds
    buffer_load_dwordx4 v3, s[52:55], s68 offen offset:1024 lds
    buffer_load_dwordx4 v4, s[52:55], s68 offen offset:2048 lds
    buffer_load_dwordx4 v5, s[52:55], s68 offen offset:3072 lds
    s_add_u32 s68, s68, 65536
    s_waitcnt vmcnt(12)
    ds_read_b64_tr_b16 v[144:145], v6 offset:49152
    ds_read_b64_tr_b16 v[146:147], v6 offset:51200
    ds_read_b64_tr_b16 v[148:149], v7 offset:49152
    ds_read_b64_tr_b16 v[150:151], v7 offset:51200
    ds_read_b64_tr_b16 v[152:153], v8 offset:49152
    ds_read_b64_tr_b16 v[154:155], v8 offset:51200
    ds_read_b64_tr_b16 v[156:157], v9 offset:49152
    ds_read_b64_tr_b16 v[158:159], v9 offset:51200
    s_waitcnt lgkmcnt(0)
    s_add_u32 m0, s74, 49152
    s_nop 0
    buffer_load_dwordx4 v2, s[52:55], s68 offen offset:0 lds
    buffer_load_dwordx4 v3, s[52:55], s68 offen offset:1024 lds
    buffer_load_dwordx4 v4, s[52:55], s68 offen offset:2048 lds
    buffer_load_dwordx4 v5, s[52:55], s68 offen offset:3072 lds
    s_add_u32 s68, s68, 65536
    s_waitcnt vmcnt(12)
    ds_read_b64_tr_b16 v[160:161], v10 offset:0
    ds_read_b64_tr_b16 v[162:163], v10 offset:2048
    ds_read_b64_tr_b16 v[164:165], v11 offset:0
    ds_read_b64_tr_b16 v[166:167], v11 offset:2048
    ds_read_b64_tr_b16 v[168:169], v12 offset:0
    ds_read_b64_tr_b16 v[170:171], v12 offset:2048
    ds_read_b64_tr_b16 v[172:173], v13 offset:0
    ds_read_b64_tr_b16 v[174:175], v13 offset:2048
    s_waitcnt lgkmcnt(0)
    s_add_u32 m0, s74, 65536
    s_nop 0
    buffer_load_dwordx4 v2, s[52:55], s68 offen offset:0 lds
    buffer_load_dwordx4 v3, s[52:55], s68 offen offset:1024 lds
    buffer_load_dwordx4 v4, s[52:55], s68 offen offset:2048 lds
    buffer_load_dwordx4 v5, s[52:55], s68 offen offset:3072 lds
    s_add_u32 s68, s68, 65536
    s_waitcnt vmcnt(12)
    ds_read_b64_tr_b16 v[176:177], v6 offset:16384
    ds_read_b64_tr_b16 v[178:179], v6 offset:18432
    ds_read_b64_tr_b16 v[180:181], v7 offset:16384
    ds_read_b64_tr_b16 v[182:183], v7 offset:18432
    ds_read_b64_tr_b16 v[184:185], v8 offset:16384
    ds_read_b64_tr_b16 v[186:187], v8 offset:18432
    ds_read_b64_tr_b16 v[188:189], v9 offset:16384
    ds_read_b64_tr_b16 v[190:191], v9 offset:18432
    s_waitcnt lgkmcnt(0)
    s_add_u32 m0, s74, 16384
    s_nop 0
    buffer_load_dwordx4 v2, s[52:55], s68 offen offset:0 lds
    buffer_load_dwordx4 v3, s[52:55], s68 offen offset:1024 lds
    buffer_load_dwordx4 v4, s[52:55], s68 offen offset:2048 lds
    buffer_load_dwordx4 v5, s[52:55], s68 offen offset:3072 lds
    s_add_u32 s68, s68, 65536
    s_barrier
    s_add_u32 m0, s74, 0
    s_nop 0
    buffer_load_dwordx4 v2, s[52:55], s68 offen offset:0 lds
    buffer_load_dwordx4 v3, s[52:55], s68 offen offset:1024 lds
    buffer_load_dwordx4 v4, s[52:55], s68 offen offset:2048 lds
    buffer_load_dwordx4 v5, s[52:55], s68 offen offset:3072 lds
    s_add_u32 s68, s68, 65536
    s_branch L_WDONE
L_IDLEB:
    s_branch L_BJOIN
L_COMPUTE:
    s_setprio 2
    s_and_b32 s32, s3, 1
    s_lshr_b32 s33, s3, 1
    v_and_b32 v16, 15, v0
    v_lshrrev_b32 v17, 4, v0
    v_lshrrev_b32 v18, 1, v16
    v_xor_b32 v18, v17, v18
    v_lshlrev_b32 v18, 4, v18
    v_lshl_add_u32 v18, v16, 7, v18
    s_lshl_b32 s34, s32, 14
    v_add_u32 v116, s34, v18
    v_xor_b32 v117, 64, v116
    v_lshrrev_b32 v18, 2, v16
    v_and_b32 v19, 3, v16
    v_lshrrev_b32 v20, 1, v18
    v_and_b32 v21, 1, v17
    v_lshl_or_b32 v20, v21, 1, v20
    s_lshl_b32 s34, s33, 1
    v_xor_b32 v20, s34, v20
    v_lshlrev_b32 v20, 5, v20
    v_lshl_add_u32 v20, v19, 3, v20
    v_lshl_add_u32 v20, v18, 7, v20
    v_lshl_add_u32 v20, v17, 10, v20
    v_add_u32 v118, 0x8000, v20
    v_xor_b32 v119, 32, v118
    v_mov_b32 v112, v116
    v_mov_b32 v113, v117
    v_mov_b32 v114, v118
    v_mov_b32 v115, v119
    v_mov_b32 v128, 0
    v_mov_b32 v129, 0
    v_mov_b32 v130, 0
    v_mov_b32 v131, 0
    v_mov_b32 v132, 0
    v_mov_b32 v133, 0
    v_mov_b32 v134, 0
    v_mov_b32 v135, 0
    v_mov_b32 v136, 0
    v_mov_b32 v137, 0
    v_mov_b32 v138, 0
    v_mov_b32 v139, 0
    v_mov_b32 v140, 0
    v_mov_b32 v141, 0
    v_mov_b32 v142, 0
    v_mov_b32 v143, 0
    v_mov_b32 v144, 0
    v_mov_b32 v145, 0
    v_mov_b32 v146, 0
    v_mov_b32 v147, 0
    v_mov_b32 v148, 0
    v_mov_b32 v149, 0
    v_mov_b32 v150, 0
    v_mov_b32 v151, 0
    v_mov_b32 v152, 0
    v_mov_b32 v153, 0
    v_mov_b32 v154, 0
    v_mov_b32 v155, 0
    v_mov_b32 v156, 0
    v_mov_b32 v157, 0
    v_mov_b32 v158, 0
    v_mov_b32 v159, 0
    v_mov_b32 v160, 0
    v_mov_b32 v161, 0
    v_mov_b32 v162, 0
    v_mov_b32 v163, 0
    v_mov_b32 v164, 0
    v_mov_b32 v165, 0
    v_mov_b32 v166, 0
    v_mov_b32 v167, 0
    v_mov_b32 v168, 0
    v_mov_b32 v169, 0
    v_mov_b32 v170, 0
    v_mov_b32 v171, 0
    v_mov_b32 v172, 0
    v_mov_b32 v173, 0
    v_mov_b32 v174, 0
    v_mov_b32 v175, 0
    v_mov_b32 v176, 0
    v_mov_b32 v177, 0
    v_mov_b32 v178, 0
    v_mov_b32 v179, 0
    v_mov_b32 v180, 0
    v_mov_b32 v181, 0
    v_mov_b32 v182, 0
    v_mov_b32 v183, 0
    v_mov_b32 v184, 0
    v_mov_b32 v185, 0
    v_mov_b32 v186, 0
    v_mov_b32 v187, 0
    v_mov_b32 v188, 0
    v_mov_b32 v189, 0
    v_mov_b32 v190, 0
    v_mov_b32 v191, 0
    v_mov_b32 v192, 0
    v_mov_b32 v193, 0
    v_mov_b32 v194, 0
    v_mov_b32 v195, 0
    v_mov_b32 v196, 0
    v_mov_b32 v197, 0
    v_mov_b32 v198, 0
    v_mov_b32 v199, 0
    v_mov_b32 v200, 0
    v_mov_b32 v201, 0
    v_mov_b32 v202, 0
    v_mov_b32 v203, 0
    v_mov_b32 v204, 0
    v_mov_b32 v205, 0
    v_mov_b32 v206, 0
    v_mov_b32 v207, 0
    v_mov_b32 v208, 0
    v_mov_b32 v209, 0
    v_mov_b32 v210, 0
    v_mov_b32 v211, 0
    v_mov_b32 v212, 0
    v_mov_b32 v213, 0
    v_mov_b32 v214, 0
    v_mov_b32 v215, 0
    v_mov_b32 v216, 0
    v_mov_b32 v217, 0
    v_mov_b32 v218, 0
    v_mov_b32 v219, 0
    v_mov_b32 v220, 0
    v_mov_b32 v221, 0
    v_mov_b32 v222, 0
    v_mov_b32 v223, 0
    v_mov_b32 v224, 0
    v_mov_b32 v225, 0
    v_mov_b32 v226, 0
    v_mov_b32 v227, 0
    v_mov_b32 v228, 0
    v_mov_b32 v229, 0
    v_mov_b32 v230, 0
    v_mov_b32 v231, 0
    v_mov_b32 v232, 0
    v_mov_b32 v233, 0
    v_mov_b32 v234, 0
    v_mov_b32 v235, 0
    v_mov_b32 v236, 0
    v_mov_b32 v237, 0
    v_mov_b32 v238, 0
    v_mov_b32 v239, 0
    v_mov_b32 v240, 0
    v_mov_b32 v241, 0
    v_mov_b32 v242, 0
    v_mov_b32 v243, 0
    v_mov_b32 v244, 0
    v_mov_b32 v245, 0
    v_mov_b32 v246, 0
    v_mov_b32 v247, 0
    v_mov_b32 v248, 0
    v_mov_b32 v249, 0
    v_mov_b32 v250, 0
    v_mov_b32 v251, 0
    v_mov_b32 v252, 0
    v_mov_b32 v253, 0
    v_mov_b32 v254, 0
    v_mov_b32 v255, 0
    v_mov_b32 v120, 0xc0135761
    v_mov_b32 v121, 0xc0135761
    s_mov_b32 s42, 0xbdd2d3e8
    s_mov_b32 s43, 0xbdd2d3e8
    s_lshl_b32 s38, s30, 2
    s_lshl_b32 s39, s32, 1
    s_add_u32 s38, s38, s39
    s_mul_i32 s38, s38, 448
    s_lshl_b32 s39, s31, 1
    s_add_u32 s39, s39, s33
    s_lshl_b32 s39, s39, 2
    s_add_u32 s38, s38, s39
    s_mul_i32 s38, s38, 1024
    s_add_u32 s39, s38, 458752
    s_lshl_b32 s40, s30, 1
    s_add_u32 s40, s40, s32
    s_lshl_b32 s40, s40, 3
    s_add_u32 s40, s40, s28
    s_lshl_b32 s40, s40, 4
    s_lshr_b32 s41, s29, 2
    s_lshl_b32 s41, s41, 1
    s_add_u32 s41, s41, s33
    s_add_u32 s40, s40, s41
    s_lshl_b32 s40, s40, 3
    s_mov_b32 s35, 0
    s_mov_b32 s36, 13
    s_waitcnt lgkmcnt(0)
    s_lshr_b32 s50, s28, 2
    s_lshl_b32 s50, s50, 3
    s_and_b32 s75, s29, 7
    s_add_u32 s50, s50, s75
    s_and_b32 s51, s28, 3
    s_lshl_b32 s51, s51, 2
    s_lshr_b32 s79, s29, 3
    s_add_u32 s51, s51, s79
    s_xor_b32 s75, s3, 4
    s_mul_i32 s75, s75, 14
    s_lshl_b32 s68, s51, 7
    s_lshl_b32 s70, s75, 16
    s_add_u32 s68, s68, s70
    s_add_u32 s70, s68, 3670016
    s_mul_i32 s72, s50, 458752
    s_mul_i32 s75, s75, 4096
    s_add_u32 s72, s72, s75
    s_and_b32 s74, s3, 3
    s_lshl_b32 s74, s74, 12
    s_lshr_b32 s75, s3, 2
    s_mul_i32 s75, s75, 81920
    s_add_u32 s74, s74, s75
    s_mov_b32 s52, s10
    s_mov_b32 s53, s11
    s_mov_b32 s54, 7340032
    s_mov_b32 s55, 0x20000
    s_mov_b32 s24, s48
    s_mov_b32 s25, s49
    s_mov_b32 s26, 7340032
    s_mov_b32 s27, 0x20000
    s_mov_b32 s56, s44
    s_mov_b32 s57, s45
    s_mov_b32 s58, 2097152
    s_mov_b32 s59, 0x20000
    s_mov_b32 s64, s46
    s_mov_b32 s65, s47
    s_mov_b32 s66, 256
    s_mov_b32 s67, 0x20000
    s_add_u32 s60, s48, 8388608
    s_addc_u32 s61, s49, 0
    s_mov_b32 s62, 8192
    s_mov_b32 s63, 0x20000
    v_lshlrev_b32 v1, 4, v0
    v_lshrrev_b32 v16, 3, v0
    v_and_b32 v17, 7, v0
    v_lshrrev_b32 v18, 4, v0
    v_lshlrev_b32 v18, 1, v18
    v_xor_b32 v17, v17, v18
    v_lshlrev_b32 v17, 4, v17
    v_lshl_add_u32 v2, v16, 11, v17
    v_add_u32 v3, 15360, v2
    v_add_u32 v4, 30720, v2
    v_add_u32 v5, 46080, v2
    v_and_b32 v16, 15, v0
    v_lshrrev_b32 v17, 4, v0
    v_lshrrev_b32 v18, 2, v16
    v_and_b32 v16, 3, v16
    v_lshrrev_b32 v19, 1, v18
    v_lshl_add_u32 v19, v17, 1, v19
    v_and_b32 v19, 3, v19
    v_lshlrev_b32 v19, 5, v19
    v_lshl_add_u32 v19, v16, 3, v19
    v_lshl_add_u32 v19, v18, 7, v19
    v_lshl_add_u32 v19, v17, 9, v19
    v_add_u32 v6, s74, v19
    v_xor_b32 v7, 32, v6
    v_xor_b32 v8, 64, v6
    v_xor_b32 v9, 96, v6
    v_add_u32 v10, 0x10000, v6
    v_add_u32 v11, 0x10000, v7
    v_add_u32 v12, 0x10000, v8
    v_add_u32 v13, 0x10000, v9
    s_barrier
    ds_read_b64_tr_b16 v[48:49], v114 offset:0
    ds_read_b64_tr_b16 v[50:51], v114 offset:512
    ds_read_b64_tr_b16 v[52:53], v115 offset:0
    ds_read_b64_tr_b16 v[54:55], v115 offset:512
    ds_read_b64_tr_b16 v[56:57], v114 offset:8192
    ds_read_b64_tr_b16 v[58:59], v114 offset:8704
    ds_read_b64_tr_b16 v[60:61], v115 offset:8192
    ds_read_b64_tr_b16 v[62:63], v115 offset:8704
    ds_read_b128 v[16:19], v112 offset:0
    ds_read_b128 v[20:23], v112 offset:2048
    ds_read_b128 v[24:27], v112 offset:4096
    ds_read_b128 v[28:31], v112 offset:6144
    ds_read_b128 v[32:35], v112 offset:8192
    ds_read_b128 v[36:39], v112 offset:10240
    ds_read_b128 v[40:43], v112 offset:12288
    ds_read_b128 v[44:47], v112 offset:14336
    .p2align 3
L_CLOOP:
    s_waitcnt lgkmcnt(0)
    v_mfma_f32_16x16x32_bf16 v[128:131], v[48:51], v[16:19], v[128:131]
    ds_read_b64_tr_b16 v[96:97], v114 offset:4096
    v_mfma_f32_16x16x32_bf16 v[132:135], v[52:55], v[16:19], v[132:135]
    ds_read_b64_tr_b16 v[98:99], v114 offset:4608
    v_mfma_f32_16x16x32_bf16 v[136:139], v[56:59], v[16:19], v[136:139]
    ds_read_b64_tr_b16 v[100:101], v115 offset:4096
    v_mfma_f32_16x16x32_bf16 v[140:143], v[60:63], v[16:19], v[140:143]
    ds_read_b64_tr_b16 v[102:103], v115 offset:4608
    v_mfma_f32_16x16x32_bf16 v[144:147], v[48:51], v[20:23], v[144:147]
    ds_read_b64_tr_b16 v[104:105], v114 offset:12288
    v_mfma_f32_16x16x32_bf16 v[148:151], v[52:55], v[20:23], v[148:151]
    ds_read_b64_tr_b16 v[106:107], v114 offset:12800
    v_mfma_f32_16x16x32_bf16 v[152:155], v[56:59], v[20:23], v[152:155]
    ds_read_b64_tr_b16 v[108:109], v115 offset:12288
    v_mfma_f32_16x16x32_bf16 v[156:159], v[60:63], v[20:23], v[156:159]
    ds_read_b64_tr_b16 v[110:111], v115 offset:12800
    v_mfma_f32_16x16x32_bf16 v[160:163], v[48:51], v[24:27], v[160:163]
    ds_read_b128 v[64:67], v113 offset:0
    v_mfma_f32_16x16x32_bf16 v[164:167], v[52:55], v[24:27], v[164:167]
    ds_read_b128 v[68:71], v113 offset:2048
    v_mfma_f32_16x16x32_bf16 v[168:171], v[56:59], v[24:27], v[168:171]
    ds_read_b128 v[72:75], v113 offset:4096
    v_mfma_f32_16x16x32_bf16 v[172:175], v[60:63], v[24:27], v[172:175]
    ds_read_b128 v[76:79], v113 offset:6144
    v_mfma_f32_16x16x32_bf16 v[176:179], v[48:51], v[28:31], v[176:179]
    ds_read_b128 v[80:83], v113 offset:8192
    v_mfma_f32_16x16x32_bf16 v[180:183], v[52:55], v[28:31], v[180:183]
    ds_read_b128 v[84:87], v113 offset:10240
    v_mfma_f32_16x16x32_bf16 v[184:187], v[56:59], v[28:31], v[184:187]
    ds_read_b128 v[88:91], v113 offset:12288
    v_mfma_f32_16x16x32_bf16 v[188:191], v[60:63], v[28:31], v[188:191]
    ds_read_b128 v[92:95], v113 offset:14336
    v_mfma_f32_16x16x32_bf16 v[192:195], v[48:51], v[32:35], v[192:195]
    s_sub_u32 s35, s35, 49152
    s_cselect_b32 s35, 98304, s35
    v_mfma_f32_16x16x32_bf16 v[196:199], v[52:55], v[32:35], v[196:199]
    s_sub_u32 s36, s36, 1
    v_mfma_f32_16x16x32_bf16 v[200:203], v[56:59], v[32:35], v[200:203]
    v_add_u32 v112, s35, v116
    v_mfma_f32_16x16x32_bf16 v[204:207], v[60:63], v[32:35], v[204:207]
    v_add_u32 v113, s35, v117
    v_mfma_f32_16x16x32_bf16 v[208:211], v[48:51], v[36:39], v[208:211]
    v_add_u32 v114, s35, v118
    v_mfma_f32_16x16x32_bf16 v[212:215], v[52:55], v[36:39], v[212:215]
    v_add_u32 v115, s35, v119
    v_mfma_f32_16x16x32_bf16 v[216:219], v[56:59], v[36:39], v[216:219]
    v_mfma_f32_16x16x32_bf16 v[220:223], v[60:63], v[36:39], v[220:223]
    v_mfma_f32_16x16x32_bf16 v[224:227], v[48:51], v[40:43], v[224:227]
    v_mfma_f32_16x16x32_bf16 v[228:231], v[52:55], v[40:43], v[228:231]
    v_mfma_f32_16x16x32_bf16 v[232:235], v[56:59], v[40:43], v[232:235]
    v_mfma_f32_16x16x32_bf16 v[236:239], v[60:63], v[40:43], v[236:239]
    v_mfma_f32_16x16x32_bf16 v[240:243], v[48:51], v[44:47], v[240:243]
    v_mfma_f32_16x16x32_bf16 v[244:247], v[52:55], v[44:47], v[244:247]
    v_mfma_f32_16x16x32_bf16 v[248:251], v[56:59], v[44:47], v[248:251]
    v_mfma_f32_16x16x32_bf16 v[252:255], v[60:63], v[44:47], v[252:255]
    s_waitcnt lgkmcnt(0)
    s_barrier
    v_mfma_f32_16x16x32_bf16 v[128:131], v[96:99], v[64:67], v[128:131]
    ds_read_b64_tr_b16 v[48:49], v114 offset:0
    v_mfma_f32_16x16x32_bf16 v[132:135], v[100:103], v[64:67], v[132:135]
    ds_read_b64_tr_b16 v[50:51], v114 offset:512
    v_mfma_f32_16x16x32_bf16 v[136:139], v[104:107], v[64:67], v[136:139]
    ds_read_b64_tr_b16 v[52:53], v115 offset:0
    v_mfma_f32_16x16x32_bf16 v[140:143], v[108:111], v[64:67], v[140:143]
    ds_read_b64_tr_b16 v[54:55], v115 offset:512
    v_mfma_f32_16x16x32_bf16 v[144:147], v[96:99], v[68:71], v[144:147]
    ds_read_b64_tr_b16 v[56:57], v114 offset:8192
    v_mfma_f32_16x16x32_bf16 v[148:151], v[100:103], v[68:71], v[148:151]
    ds_read_b64_tr_b16 v[58:59], v114 offset:8704
    v_mfma_f32_16x16x32_bf16 v[152:155], v[104:107], v[68:71], v[152:155]
    ds_read_b64_tr_b16 v[60:61], v115 offset:8192
    v_mfma_f32_16x16x32_bf16 v[156:159], v[108:111], v[68:71], v[156:159]
    ds_read_b64_tr_b16 v[62:63], v115 offset:8704
    v_mfma_f32_16x16x32_bf16 v[160:163], v[96:99], v[72:75], v[160:163]
    ds_read_b128 v[16:19], v112 offset:0
    v_mfma_f32_16x16x32_bf16 v[164:167], v[100:103], v[72:75], v[164:167]
    ds_read_b128 v[20:23], v112 offset:2048
    v_mfma_f32_16x16x32_bf16 v[168:171], v[104:107], v[72:75], v[168:171]
    ds_read_b128 v[24:27], v112 offset:4096
    v_mfma_f32_16x16x32_bf16 v[172:175], v[108:111], v[72:75], v[172:175]
    ds_read_b128 v[28:31], v112 offset:6144
    v_mfma_f32_16x16x32_bf16 v[176:179], v[96:99], v[76:79], v[176:179]
    ds_read_b128 v[32:35], v112 offset:8192
    v_mfma_f32_16x16x32_bf16 v[180:183], v[100:103], v[76:79], v[180:183]
    ds_read_b128 v[36:39], v112 offset:10240
    v_mfma_f32_16x16x32_bf16 v[184:187], v[104:107], v[76:79], v[184:187]
    ds_read_b128 v[40:43], v112 offset:12288
    v_mfma_f32_16x16x32_bf16 v[188:191], v[108:111], v[76:79], v[188:191]
    ds_read_b128 v[44:47], v112 offset:14336
    v_mfma_f32_16x16x32_bf16 v[192:195], v[96:99], v[80:83], v[192:195]
    v_mfma_f32_16x16x32_bf16 v[196:199], v[100:103], v[80:83], v[196:199]
    v_mfma_f32_16x16x32_bf16 v[200:203], v[104:107], v[80:83], v[200:203]
    v_mfma_f32_16x16x32_bf16 v[204:207], v[108:111], v[80:83], v[204:207]
    v_mfma_f32_16x16x32_bf16 v[208:211], v[96:99], v[84:87], v[208:211]
    v_mfma_f32_16x16x32_bf16 v[212:215], v[100:103], v[84:87], v[212:215]
    v_mfma_f32_16x16x32_bf16 v[216:219], v[104:107], v[84:87], v[216:219]
    v_mfma_f32_16x16x32_bf16 v[220:223], v[108:111], v[84:87], v[220:223]
    v_mfma_f32_16x16x32_bf16 v[224:227], v[96:99], v[88:91], v[224:227]
    v_mfma_f32_16x16x32_bf16 v[228:231], v[100:103], v[88:91], v[228:231]
    v_mfma_f32_16x16x32_bf16 v[232:235], v[104:107], v[88:91], v[232:235]
    v_mfma_f32_16x16x32_bf16 v[236:239], v[108:111], v[88:91], v[236:239]
    v_mfma_f32_16x16x32_bf16 v[240:243], v[96:99], v[92:95], v[240:243]
    v_mfma_f32_16x16x32_bf16 v[244:247], v[100:103], v[92:95], v[244:247]
    v_mfma_f32_16x16x32_bf16 v[248:251], v[104:107], v[92:95], v[248:251]
    v_mfma_f32_16x16x32_bf16 v[252:255], v[108:111], v[92:95], v[252:255]
    s_cmp_lg_u32 s36, 0
    s_cbranch_scc1 L_CLOOP
    s_waitcnt lgkmcnt(0)
    v_mfma_f32_16x16x32_bf16 v[128:131], v[48:51], v[16:19], v[128:131]
    ds_read_b64_tr_b16 v[96:97], v114 offset:4096
    v_mfma_f32_16x16x32_bf16 v[132:135], v[52:55], v[16:19], v[132:135]
    ds_read_b64_tr_b16 v[98:99], v114 offset:4608
    v_mfma_f32_16x16x32_bf16 v[136:139], v[56:59], v[16:19], v[136:139]
    ds_read_b64_tr_b16 v[100:101], v115 offset:4096
    v_mfma_f32_16x16x32_bf16 v[140:143], v[60:63], v[16:19], v[140:143]
    ds_read_b64_tr_b16 v[102:103], v115 offset:4608
    v_mfma_f32_16x16x32_bf16 v[144:147], v[48:51], v[20:23], v[144:147]
    ds_read_b64_tr_b16 v[104:105], v114 offset:12288
    v_mfma_f32_16x16x32_bf16 v[148:151], v[52:55], v[20:23], v[148:151]
    ds_read_b64_tr_b16 v[106:107], v114 offset:12800
    v_mfma_f32_16x16x32_bf16 v[152:155], v[56:59], v[20:23], v[152:155]
    ds_read_b64_tr_b16 v[108:109], v115 offset:12288
    v_mfma_f32_16x16x32_bf16 v[156:159], v[60:63], v[20:23], v[156:159]
    ds_read_b64_tr_b16 v[110:111], v115 offset:12800
    v_mfma_f32_16x16x32_bf16 v[160:163], v[48:51], v[24:27], v[160:163]
    ds_read_b128 v[64:67], v113 offset:0
    v_mfma_f32_16x16x32_bf16 v[164:167], v[52:55], v[24:27], v[164:167]
    ds_read_b128 v[68:71], v113 offset:2048
    v_mfma_f32_16x16x32_bf16 v[168:171], v[56:59], v[24:27], v[168:171]
    ds_read_b128 v[72:75], v113 offset:4096
    v_mfma_f32_16x16x32_bf16 v[172:175], v[60:63], v[24:27], v[172:175]
    ds_read_b128 v[76:79], v113 offset:6144
    v_mfma_f32_16x16x32_bf16 v[176:179], v[48:51], v[28:31], v[176:179]
    ds_read_b128 v[80:83], v113 offset:8192
    v_mfma_f32_16x16x32_bf16 v[180:183], v[52:55], v[28:31], v[180:183]
    ds_read_b128 v[84:87], v113 offset:10240
    v_mfma_f32_16x16x32_bf16 v[184:187], v[56:59], v[28:31], v[184:187]
    ds_read_b128 v[88:91], v113 offset:12288
    v_mfma_f32_16x16x32_bf16 v[188:191], v[60:63], v[28:31], v[188:191]
    ds_read_b128 v[92:95], v113 offset:14336
    v_mfma_f32_16x16x32_bf16 v[192:195], v[48:51], v[32:35], v[192:195]
    v_mfma_f32_16x16x32_bf16 v[196:199], v[52:55], v[32:35], v[196:199]
    v_mfma_f32_16x16x32_bf16 v[200:203], v[56:59], v[32:35], v[200:203]
    v_mfma_f32_16x16x32_bf16 v[204:207], v[60:63], v[32:35], v[204:207]
    v_mfma_f32_16x16x32_bf16 v[208:211], v[48:51], v[36:39], v[208:211]
    v_mfma_f32_16x16x32_bf16 v[212:215], v[52:55], v[36:39], v[212:215]
    v_mfma_f32_16x16x32_bf16 v[216:219], v[56:59], v[36:39], v[216:219]
    v_mfma_f32_16x16x32_bf16 v[220:223], v[60:63], v[36:39], v[220:223]
    v_mfma_f32_16x16x32_bf16 v[224:227], v[48:51], v[40:43], v[224:227]
    v_mfma_f32_16x16x32_bf16 v[228:231], v[52:55], v[40:43], v[228:231]
    v_mfma_f32_16x16x32_bf16 v[232:235], v[56:59], v[40:43], v[232:235]
    v_mfma_f32_16x16x32_bf16 v[236:239], v[60:63], v[40:43], v[236:239]
    v_mfma_f32_16x16x32_bf16 v[240:243], v[48:51], v[44:47], v[240:243]
    v_mfma_f32_16x16x32_bf16 v[244:247], v[52:55], v[44:47], v[244:247]
    v_mfma_f32_16x16x32_bf16 v[248:251], v[56:59], v[44:47], v[248:251]
    v_mfma_f32_16x16x32_bf16 v[252:255], v[60:63], v[44:47], v[252:255]
    s_waitcnt lgkmcnt(0)
    s_barrier
    v_mfma_f32_16x16x32_bf16 v[128:131], v[96:99], v[64:67], v[128:131]
    ds_read_b64_tr_b16 v[48:49], v118 offset:49152
    v_mfma_f32_16x16x32_bf16 v[132:135], v[100:103], v[64:67], v[132:135]
    ds_read_b64_tr_b16 v[50:51], v118 offset:49664
    v_mfma_f32_16x16x32_bf16 v[136:139], v[104:107], v[64:67], v[136:139]
    ds_read_b64_tr_b16 v[52:53], v119 offset:49152
    v_mfma_f32_16x16x32_bf16 v[140:143], v[108:111], v[64:67], v[140:143]
    ds_read_b64_tr_b16 v[54:55], v119 offset:49664
    v_mfma_f32_16x16x32_bf16 v[144:147], v[96:99], v[68:71], v[144:147]
    ds_read_b64_tr_b16 v[56:57], v118 offset:57344
    v_mfma_f32_16x16x32_bf16 v[148:151], v[100:103], v[68:71], v[148:151]
    ds_read_b64_tr_b16 v[58:59], v118 offset:57856
    v_mfma_f32_16x16x32_bf16 v[152:155], v[104:107], v[68:71], v[152:155]
    ds_read_b64_tr_b16 v[60:61], v119 offset:57344
    v_mfma_f32_16x16x32_bf16 v[156:159], v[108:111], v[68:71], v[156:159]
    ds_read_b64_tr_b16 v[62:63], v119 offset:57856
    v_mfma_f32_16x16x32_bf16 v[160:163], v[96:99], v[72:75], v[160:163]
    ds_read_b128 v[32:35], v116 offset:49152
    v_mfma_f32_16x16x32_bf16 v[164:167], v[100:103], v[72:75], v[164:167]
    ds_read_b128 v[36:39], v117 offset:49152
    v_mfma_f32_16x16x32_bf16 v[168:171], v[104:107], v[72:75], v[168:171]
    ds_read_b64_tr_b16 v[16:17], v118 offset:53248
    v_mfma_f32_16x16x32_bf16 v[172:175], v[108:111], v[72:75], v[172:175]
    ds_read_b64_tr_b16 v[18:19], v118 offset:53760
    v_mfma_f32_16x16x32_bf16 v[176:179], v[96:99], v[76:79], v[176:179]
    ds_read_b64_tr_b16 v[20:21], v119 offset:53248
    v_mfma_f32_16x16x32_bf16 v[180:183], v[100:103], v[76:79], v[180:183]
    ds_read_b64_tr_b16 v[22:23], v119 offset:53760
    v_mfma_f32_16x16x32_bf16 v[184:187], v[104:107], v[76:79], v[184:187]
    ds_read_b64_tr_b16 v[24:25], v118 offset:61440
    v_mfma_f32_16x16x32_bf16 v[188:191], v[108:111], v[76:79], v[188:191]
    ds_read_b64_tr_b16 v[26:27], v118 offset:61952
    v_mfma_f32_16x16x32_bf16 v[192:195], v[96:99], v[80:83], v[192:195]
    ds_read_b64_tr_b16 v[28:29], v119 offset:61440
    v_mfma_f32_16x16x32_bf16 v[196:199], v[100:103], v[80:83], v[196:199]
    ds_read_b64_tr_b16 v[30:31], v119 offset:61952
    v_mfma_f32_16x16x32_bf16 v[200:203], v[104:107], v[80:83], v[200:203]
    ds_read_b128 v[40:43], v116 offset:51200
    v_mfma_f32_16x16x32_bf16 v[204:207], v[108:111], v[80:83], v[204:207]
    ds_read_b128 v[44:47], v117 offset:51200
    v_mfma_f32_16x16x32_bf16 v[208:211], v[96:99], v[84:87], v[208:211]
    v_mfma_f32_16x16x32_bf16 v[212:215], v[100:103], v[84:87], v[212:215]
    v_mfma_f32_16x16x32_bf16 v[216:219], v[104:107], v[84:87], v[216:219]
    v_mfma_f32_16x16x32_bf16 v[220:223], v[108:111], v[84:87], v[220:223]
    v_mfma_f32_16x16x32_bf16 v[224:227], v[96:99], v[88:91], v[224:227]
    v_mfma_f32_16x16x32_bf16 v[228:231], v[100:103], v[88:91], v[228:231]
    v_mfma_f32_16x16x32_bf16 v[232:235], v[104:107], v[88:91], v[232:235]
    v_mfma_f32_16x16x32_bf16 v[236:239], v[108:111], v[88:91], v[236:239]
    v_mfma_f32_16x16x32_bf16 v[240:243], v[96:99], v[92:95], v[240:243]
    v_mfma_f32_16x16x32_bf16 v[244:247], v[100:103], v[92:95], v[244:247]
    v_mfma_f32_16x16x32_bf16 v[248:251], v[104:107], v[92:95], v[248:251]
    v_mfma_f32_16x16x32_bf16 v[252:255], v[108:111], v[92:95], v[252:255]
    s_waitcnt vmcnt(0) lgkmcnt(0)
    s_barrier
    buffer_load_dwordx2 v[14:15], off, s[64:67], 0 sc1
    v_mfma_f32_16x16x32_bf16 v[128:131], v[48:51], v[32:35], v[128:131]
    ds_read_b128 v[80:83], v116 offset:0
    ds_read_b128 v[84:87], v117 offset:0
    v_mfma_f32_16x16x32_bf16 v[132:135], v[52:55], v[32:35], v[132:135]
    ds_read_b64_tr_b16 v[96:97], v118 offset:0
    ds_read_b64_tr_b16 v[98:99], v118 offset:512
    v_mfma_f32_16x16x32_bf16 v[136:139], v[56:59], v[32:35], v[136:139]
    ds_read_b64_tr_b16 v[100:101], v119 offset:0
    v_mfma_f32_16x16x32_bf16 v[140:143], v[60:63], v[32:35], v[140:143]
    ds_read_b64_tr_b16 v[102:103], v119 offset:512
    v_mfma_f32_16x16x32_bf16 v[128:131], v[16:19], v[36:39], v[128:131]
    ds_read_b64_tr_b16 v[104:105], v118 offset:8192
    v_mfma_f32_16x16x32_bf16 v[132:135], v[20:23], v[36:39], v[132:135]
    ds_read_b64_tr_b16 v[106:107], v118 offset:8704
    v_mfma_f32_16x16x32_bf16 v[136:139], v[24:27], v[36:39], v[136:139]
    ds_read_b64_tr_b16 v[108:109], v119 offset:8192
    v_mfma_f32_16x16x32_bf16 v[140:143], v[28:31], v[36:39], v[140:143]
    ds_read_b64_tr_b16 v[110:111], v119 offset:8704
    v_mfma_f32_16x16x32_bf16 v[144:147], v[48:51], v[40:43], v[144:147]
    ds_read_b64_tr_b16 v[64:65], v118 offset:4096
    ds_read_b64_tr_b16 v[66:67], v118 offset:4608
    v_mfma_f32_16x16x32_bf16 v[148:151], v[52:55], v[40:43], v[148:151]
    ds_read_b64_tr_b16 v[68:69], v119 offset:4096
    ds_read_b64_tr_b16 v[70:71], v119 offset:4608
    v_mfma_f32_16x16x32_bf16 v[152:155], v[56:59], v[40:43], v[152:155]
    ds_read_b64_tr_b16 v[72:73], v118 offset:12288
    ds_read_b64_tr_b16 v[74:75], v118 offset:12800
    v_mfma_f32_16x16x32_bf16 v[156:159], v[60:63], v[40:43], v[156:159]
    ds_read_b64_tr_b16 v[76:77], v119 offset:12288
    ds_read_b64_tr_b16 v[78:79], v119 offset:12800
    v_mfma_f32_16x16x32_bf16 v[144:147], v[16:19], v[44:47], v[144:147]
    ds_read_b128 v[88:91], v116 offset:2048
    v_mfma_f32_16x16x32_bf16 v[148:151], v[20:23], v[44:47], v[148:151]
    ds_read_b128 v[92:95], v117 offset:2048
    v_mfma_f32_16x16x32_bf16 v[152:155], v[24:27], v[44:47], v[152:155]
    ds_read_b128 v[32:35], v116 offset:53248
    v_mfma_f32_16x16x32_bf16 v[156:159], v[28:31], v[44:47], v[156:159]
    ds_read_b128 v[36:39], v117 offset:53248
    s_waitcnt lgkmcnt(12)
    v_mfma_f32_16x16x32_bf16 v[128:131], v[96:99], v[80:83], v[128:131]
    v_mfma_f32_16x16x32_bf16 v[132:135], v[100:103], v[80:83], v[132:135]
    ds_read_b128 v[40:43], v116 offset:55296
    v_mfma_f32_16x16x32_bf16 v[136:139], v[104:107], v[80:83], v[136:139]
    ds_read_b128 v[44:47], v117 offset:55296
    v_mfma_f32_16x16x32_bf16 v[140:143], v[108:111], v[80:83], v[140:143]
    s_waitcnt lgkmcnt(6)
    v_mfma_f32_16x16x32_bf16 v[128:131], v[64:67], v[84:87], v[128:131]
    v_mfma_f32_16x16x32_bf16 v[132:135], v[68:71], v[84:87], v[132:135]
    v_mfma_f32_16x16x32_bf16 v[136:139], v[72:75], v[84:87], v[136:139]
    v_mfma_f32_16x16x32_bf16 v[140:143], v[76:79], v[84:87], v[140:143]
    s_waitcnt lgkmcnt(5)
    v_mfma_f32_16x16x32_bf16 v[144:147], v[96:99], v[88:91], v[144:147]
    v_mfma_f32_16x16x32_bf16 v[148:151], v[100:103], v[88:91], v[148:151]
    ds_read_b128 v[80:83], v116 offset:4096
    v_mfma_f32_16x16x32_bf16 v[152:155], v[104:107], v[88:91], v[152:155]
    ds_read_b128 v[84:87], v117 offset:4096
    v_mfma_f32_16x16x32_bf16 v[156:159], v[108:111], v[88:91], v[156:159]
    s_waitcnt lgkmcnt(6)
    v_mfma_f32_16x16x32_bf16 v[144:147], v[64:67], v[92:95], v[144:147]
    v_pk_mul_f32 v[112:113], v[128:129], v[128:129]
    v_pk_mul_f32 v[114:115], v[130:131], v[130:131]
    v_pk_mul_f32 v[124:125], v[132:133], v[132:133]
    v_pk_mul_f32 v[126:127], v[134:135], v[134:135]
    v_pk_mul_f32 v[136:137], v[128:129], v[136:137]
    v_pk_mul_f32 v[138:139], v[130:131], v[138:139]
    v_pk_mul_f32 v[140:141], v[132:133], v[140:141]
    v_pk_mul_f32 v[142:143], v[134:135], v[142:143]
    v_pk_fma_f32 v[112:113], v[112:113], s[42:43], v[120:121]
    v_pk_fma_f32 v[114:115], v[114:115], s[42:43], v[120:121]
    v_pk_fma_f32 v[124:125], v[124:125], s[42:43], v[120:121]
    v_pk_fma_f32 v[126:127], v[126:127], s[42:43], v[120:121]
    v_pk_mul_f32 v[128:129], v[112:113], v[128:129]
    v_pk_mul_f32 v[130:131], v[114:115], v[130:131]
    v_pk_mul_f32 v[132:133], v[124:125], v[132:133]
    v_pk_mul_f32 v[134:135], v[126:127], v[134:135]
    v_mfma_f32_16x16x32_bf16 v[148:151], v[68:71], v[92:95], v[148:151]
    v_exp_f32 v128, v128
    v_mfma_f32_16x16x32_bf16 v[152:155], v[72:75], v[92:95], v[152:155]
    v_exp_f32 v129, v129
    v_mfma_f32_16x16x32_bf16 v[156:159], v[76:79], v[92:95], v[156:159]
    v_exp_f32 v130, v130
    s_waitcnt lgkmcnt(5)
    v_mfma_f32_16x16x32_bf16 v[160:163], v[48:51], v[32:35], v[160:163]
    v_exp_f32 v131, v131
    v_mfma_f32_16x16x32_bf16 v[164:167], v[52:55], v[32:35], v[164:167]
    ds_read_b128 v[88:91], v116 offset:6144
    v_exp_f32 v132, v132
    v_mfma_f32_16x16x32_bf16 v[168:171], v[56:59], v[32:35], v[168:171]
    ds_read_b128 v[92:95], v117 offset:6144
    v_exp_f32 v133, v133
    v_mfma_f32_16x16x32_bf16 v[172:175], v[60:63], v[32:35], v[172:175]
    v_exp_f32 v134, v134
    s_waitcnt lgkmcnt(6)
    v_mfma_f32_16x16x32_bf16 v[160:163], v[16:19], v[36:39], v[160:163]
    v_exp_f32 v135, v135
    v_mfma_f32_16x16x32_bf16 v[164:167], v[20:23], v[36:39], v[164:167]
    v_pk_add_f32 v[128:129], v[128:129], 1.0 op_sel_hi:[1,0]
    v_pk_add_f32 v[130:131], v[130:131], 1.0 op_sel_hi:[1,0]
    v_pk_add_f32 v[132:133], v[132:133], 1.0 op_sel_hi:[1,0]
    v_pk_add_f32 v[134:135], v[134:135], 1.0 op_sel_hi:[1,0]
    v_pk_mul_f32 v[112:113], v[144:145], v[144:145]
    v_pk_mul_f32 v[114:115], v[146:147], v[146:147]
    v_pk_mul_f32 v[124:125], v[148:149], v[148:149]
    v_pk_mul_f32 v[126:127], v[150:151], v[150:151]
    v_pk_mul_f32 v[152:153], v[144:145], v[152:153]
    v_pk_mul_f32 v[154:155], v[146:147], v[154:155]
    v_pk_mul_f32 v[156:157], v[148:149], v[156:157]
    v_pk_mul_f32 v[158:159], v[150:151], v[158:159]
    v_pk_fma_f32 v[112:113], v[112:113], s[42:43], v[120:121]
    v_pk_fma_f32 v[114:115], v[114:115], s[42:43], v[120:121]
    v_pk_fma_f32 v[124:125], v[124:125], s[42:43], v[120:121]
    v_pk_fma_f32 v[126:127], v[126:127], s[42:43], v[120:121]
    v_pk_mul_f32 v[144:145], v[112:113], v[144:145]
    v_pk_mul_f32 v[146:147], v[114:115], v[146:147]
    v_pk_mul_f32 v[148:149], v[124:125], v[148:149]
    v_pk_mul_f32 v[150:151], v[126:127], v[150:151]
    v_mfma_f32_16x16x32_bf16 v[168:171], v[24:27], v[36:39], v[168:171]
    v_rcp_f32 v128, v128
    v_mfma_f32_16x16x32_bf16 v[172:175], v[28:31], v[36:39], v[172:175]
    v_rcp_f32 v129, v129
    s_waitcnt lgkmcnt(3)
    v_mfma_f32_16x16x32_bf16 v[160:163], v[96:99], v[80:83], v[160:163]
    v_rcp_f32 v130, v130
    v_mfma_f32_16x16x32_bf16 v[164:167], v[100:103], v[80:83], v[164:167]
    ds_read_b128 v[32:35], v116 offset:57344
    v_rcp_f32 v131, v131
    v_mfma_f32_16x16x32_bf16 v[168:171], v[104:107], v[80:83], v[168:171]
    ds_read_b128 v[36:39], v117 offset:57344
    v_rcp_f32 v132, v132
    v_mfma_f32_16x16x32_bf16 v[172:175], v[108:111], v[80:83], v[172:175]
    v_rcp_f32 v133, v133
    s_waitcnt lgkmcnt(4)
    v_mfma_f32_16x16x32_bf16 v[160:163], v[64:67], v[84:87], v[160:163]
    v_rcp_f32 v134, v134
    v_mfma_f32_16x16x32_bf16 v[164:167], v[68:71], v[84:87], v[164:167]
    v_rcp_f32 v135, v135
    v_mfma_f32_16x16x32_bf16 v[168:171], v[72:75], v[84:87], v[168:171]
    v_exp_f32 v144, v144
    v_mfma_f32_16x16x32_bf16 v[172:175], v[76:79], v[84:87], v[172:175]
    v_exp_f32 v145, v145
    v_mfma_f32_16x16x32_bf16 v[176:179], v[48:51], v[40:43], v[176:179]
    v_exp_f32 v146, v146
    v_mfma_f32_16x16x32_bf16 v[180:183], v[52:55], v[40:43], v[180:183]
    ds_read_b128 v[80:83], v116 offset:8192
    v_exp_f32 v147, v147
    v_mfma_f32_16x16x32_bf16 v[184:187], v[56:59], v[40:43], v[184:187]
    ds_read_b128 v[84:87], v117 offset:8192
    v_exp_f32 v148, v148
    v_mfma_f32_16x16x32_bf16 v[188:191], v[60:63], v[40:43], v[188:191]
    v_exp_f32 v149, v149
    v_mfma_f32_16x16x32_bf16 v[176:179], v[16:19], v[44:47], v[176:179]
    v_exp_f32 v150, v150
    v_mfma_f32_16x16x32_bf16 v[180:183], v[20:23], v[44:47], v[180:183]
    v_exp_f32 v151, v151
    v_mfma_f32_16x16x32_bf16 v[184:187], v[24:27], v[44:47], v[184:187]
    v_pk_mul_f32 v[128:129], v[128:129], v[136:137]
    v_pk_mul_f32 v[130:131], v[130:131], v[138:139]
    v_pk_mul_f32 v[132:133], v[132:133], v[140:141]
    v_pk_mul_f32 v[134:135], v[134:135], v[142:143]
    v_cvt_pk_bf16_f32 v128, v128, v129
    v_cvt_pk_bf16_f32 v129, v130, v131
    v_cvt_pk_bf16_f32 v130, v132, v133
    v_cvt_pk_bf16_f32 v131, v134, v135
    buffer_store_dwordx4 v[128:131], v1, s[24:27], s38 offen offset:0 sc1
    v_pk_add_f32 v[144:145], v[144:145], 1.0 op_sel_hi:[1,0]
    v_pk_add_f32 v[146:147], v[146:147], 1.0 op_sel_hi:[1,0]
    v_pk_add_f32 v[148:149], v[148:149], 1.0 op_sel_hi:[1,0]
    v_pk_add_f32 v[150:151], v[150:151], 1.0 op_sel_hi:[1,0]
    v_pk_mul_f32 v[112:113], v[160:161], v[160:161]
    v_pk_mul_f32 v[114:115], v[162:163], v[162:163]
    v_pk_mul_f32 v[124:125], v[164:165], v[164:165]
    v_pk_mul_f32 v[126:127], v[166:167], v[166:167]
    v_pk_mul_f32 v[168:169], v[160:161], v[168:169]
    v_pk_mul_f32 v[170:171], v[162:163], v[170:171]
    v_pk_mul_f32 v[172:173], v[164:165], v[172:173]
    v_pk_mul_f32 v[174:175], v[166:167], v[174:175]
    v_pk_fma_f32 v[112:113], v[112:113], s[42:43], v[120:121]
    v_pk_fma_f32 v[114:115], v[114:115], s[42:43], v[120:121]
    v_pk_fma_f32 v[124:125], v[124:125], s[42:43], v[120:121]
    v_pk_fma_f32 v[126:127], v[126:127], s[42:43], v[120:121]
    v_pk_mul_f32 v[160:161], v[112:113], v[160:161]
    v_pk_mul_f32 v[162:163], v[114:115], v[162:163]
    v_pk_mul_f32 v[164:165], v[124:125], v[164:165]
    v_pk_mul_f32 v[166:167], v[126:127], v[166:167]
    v_mfma_f32_16x16x32_bf16 v[188:191], v[28:31], v[44:47], v[188:191]
    v_rcp_f32 v144, v144
    s_waitcnt lgkmcnt(5)
    v_mfma_f32_16x16x32_bf16 v[176:179], v[96:99], v[88:91], v[176:179]
    v_rcp_f32 v145, v145
    v_mfma_f32_16x16x32_bf16 v[180:183], v[100:103], v[88:91], v[180:183]
    ds_read_b128 v[40:43], v116 offset:59392
    v_rcp_f32 v146, v146
    v_mfma_f32_16x16x32_bf16 v[184:187], v[104:107], v[88:91], v[184:187]
    ds_read_b128 v[44:47], v117 offset:59392
    v_rcp_f32 v147, v147
    v_mfma_f32_16x16x32_bf16 v[188:191], v[108:111], v[88:91], v[188:191]
    v_rcp_f32 v148, v148
    s_waitcnt lgkmcnt(6)
    v_mfma_f32_16x16x32_bf16 v[176:179], v[64:67], v[92:95], v[176:179]
    v_rcp_f32 v149, v149
    v_mfma_f32_16x16x32_bf16 v[180:183], v[68:71], v[92:95], v[180:183]
    v_rcp_f32 v150, v150
    v_mfma_f32_16x16x32_bf16 v[184:187], v[72:75], v[92:95], v[184:187]
    v_rcp_f32 v151, v151
    v_mfma_f32_16x16x32_bf16 v[188:191], v[76:79], v[92:95], v[188:191]
    v_exp_f32 v160, v160
    s_waitcnt lgkmcnt(5)
    v_mfma_f32_16x16x32_bf16 v[192:195], v[48:51], v[32:35], v[192:195]
    v_exp_f32 v161, v161
    v_mfma_f32_16x16x32_bf16 v[196:199], v[52:55], v[32:35], v[196:199]
    ds_read_b128 v[88:91], v116 offset:10240
    v_exp_f32 v162, v162
    v_mfma_f32_16x16x32_bf16 v[200:203], v[56:59], v[32:35], v[200:203]
    ds_read_b128 v[92:95], v117 offset:10240
    v_exp_f32 v163, v163
    v_mfma_f32_16x16x32_bf16 v[204:207], v[60:63], v[32:35], v[204:207]
    v_exp_f32 v164, v164
    s_waitcnt lgkmcnt(6)
    v_mfma_f32_16x16x32_bf16 v[192:195], v[16:19], v[36:39], v[192:195]
    v_exp_f32 v165, v165
    v_mfma_f32_16x16x32_bf16 v[196:199], v[20:23], v[36:39], v[196:199]
    v_exp_f32 v166, v166
    v_mfma_f32_16x16x32_bf16 v[200:203], v[24:27], v[36:39], v[200:203]
    v_exp_f32 v167, v167
    v_mfma_f32_16x16x32_bf16 v[204:207], v[28:31], v[36:39], v[204:207]
    v_pk_mul_f32 v[144:145], v[144:145], v[152:153]
    v_pk_mul_f32 v[146:147], v[146:147], v[154:155]
    v_pk_mul_f32 v[148:149], v[148:149], v[156:157]
    v_pk_mul_f32 v[150:151], v[150:151], v[158:159]
    v_cvt_pk_bf16_f32 v144, v144, v145
    v_cvt_pk_bf16_f32 v145, v146, v147
    v_cvt_pk_bf16_f32 v146, v148, v149
    v_cvt_pk_bf16_f32 v147, v150, v151
    buffer_store_dwordx4 v[144:147], v1, s[24:27], s38 offen offset:1024 sc1
    v_pk_add_f32 v[160:161], v[160:161], 1.0 op_sel_hi:[1,0]
    v_pk_add_f32 v[162:163], v[162:163], 1.0 op_sel_hi:[1,0]
    v_pk_add_f32 v[164:165], v[164:165], 1.0 op_sel_hi:[1,0]
    v_pk_add_f32 v[166:167], v[166:167], 1.0 op_sel_hi:[1,0]
    v_pk_mul_f32 v[112:113], v[176:177], v[176:177]
    v_pk_mul_f32 v[114:115], v[178:179], v[178:179]
    v_pk_mul_f32 v[124:125], v[180:181], v[180:181]
    v_pk_mul_f32 v[126:127], v[182:183], v[182:183]
    v_pk_mul_f32 v[184:185], v[176:177], v[184:185]
    v_pk_mul_f32 v[186:187], v[178:179], v[186:187]
    v_pk_mul_f32 v[188:189], v[180:181], v[188:189]
    v_pk_mul_f32 v[190:191], v[182:183], v[190:191]
    v_pk_fma_f32 v[112:113], v[112:113], s[42:43], v[120:121]
    v_pk_fma_f32 v[114:115], v[114:115], s[42:43], v[120:121]
    v_pk_fma_f32 v[124:125], v[124:125], s[42:43], v[120:121]
    v_pk_fma_f32 v[126:127], v[126:127], s[42:43], v[120:121]
    v_pk_mul_f32 v[176:177], v[112:113], v[176:177]
    v_pk_mul_f32 v[178:179], v[114:115], v[178:179]
    v_pk_mul_f32 v[180:181], v[124:125], v[180:181]
    v_pk_mul_f32 v[182:183], v[126:127], v[182:183]
    s_waitcnt lgkmcnt(5)
    v_mfma_f32_16x16x32_bf16 v[192:195], v[96:99], v[80:83], v[192:195]
    v_rcp_f32 v160, v160
    v_mfma_f32_16x16x32_bf16 v[196:199], v[100:103], v[80:83], v[196:199]
    ds_read_b128 v[32:35], v116 offset:61440
    v_rcp_f32 v161, v161
    v_mfma_f32_16x16x32_bf16 v[200:203], v[104:107], v[80:83], v[200:203]
    ds_read_b128 v[36:39], v117 offset:61440
    v_rcp_f32 v162, v162
    v_mfma_f32_16x16x32_bf16 v[204:207], v[108:111], v[80:83], v[204:207]
    v_rcp_f32 v163, v163
    s_waitcnt lgkmcnt(6)
    v_mfma_f32_16x16x32_bf16 v[192:195], v[64:67], v[84:87], v[192:195]
    v_rcp_f32 v164, v164
    v_mfma_f32_16x16x32_bf16 v[196:199], v[68:71], v[84:87], v[196:199]
    v_rcp_f32 v165, v165
    v_mfma_f32_16x16x32_bf16 v[200:203], v[72:75], v[84:87], v[200:203]
    v_rcp_f32 v166, v166
    v_mfma_f32_16x16x32_bf16 v[204:207], v[76:79], v[84:87], v[204:207]
    v_rcp_f32 v167, v167
    s_waitcnt lgkmcnt(5)
    v_mfma_f32_16x16x32_bf16 v[208:211], v[48:51], v[40:43], v[208:211]
    v_exp_f32 v176, v176
    v_mfma_f32_16x16x32_bf16 v[212:215], v[52:55], v[40:43], v[212:215]
    ds_read_b128 v[80:83], v116 offset:12288
    v_exp_f32 v177, v177
    v_mfma_f32_16x16x32_bf16 v[216:219], v[56:59], v[40:43], v[216:219]
    ds_read_b128 v[84:87], v117 offset:12288
    v_exp_f32 v178, v178
    v_mfma_f32_16x16x32_bf16 v[220:223], v[60:63], v[40:43], v[220:223]
    v_exp_f32 v179, v179
    s_waitcnt lgkmcnt(6)
    v_mfma_f32_16x16x32_bf16 v[208:211], v[16:19], v[44:47], v[208:211]
    v_exp_f32 v180, v180
    v_mfma_f32_16x16x32_bf16 v[212:215], v[20:23], v[44:47], v[212:215]
    v_exp_f32 v181, v181
    v_mfma_f32_16x16x32_bf16 v[216:219], v[24:27], v[44:47], v[216:219]
    v_exp_f32 v182, v182
    v_mfma_f32_16x16x32_bf16 v[220:223], v[28:31], v[44:47], v[220:223]
    v_exp_f32 v183, v183
    s_waitcnt lgkmcnt(5)
    v_mfma_f32_16x16x32_bf16 v[208:211], v[96:99], v[88:91], v[208:211]
    v_pk_mul_f32 v[160:161], v[160:161], v[168:169]
    v_pk_mul_f32 v[162:163], v[162:163], v[170:171]
    v_pk_mul_f32 v[164:165], v[164:165], v[172:173]
    v_pk_mul_f32 v[166:167], v[166:167], v[174:175]
    v_cvt_pk_bf16_f32 v160, v160, v161
    v_cvt_pk_bf16_f32 v161, v162, v163
    v_cvt_pk_bf16_f32 v162, v164, v165
    v_cvt_pk_bf16_f32 v163, v166, v167
    buffer_store_dwordx4 v[160:163], v1, s[24:27], s38 offen offset:2048 sc1
    v_pk_add_f32 v[176:177], v[176:177], 1.0 op_sel_hi:[1,0]
    v_pk_add_f32 v[178:179], v[178:179], 1.0 op_sel_hi:[1,0]
    v_pk_add_f32 v[180:181], v[180:181], 1.0 op_sel_hi:[1,0]
    v_pk_add_f32 v[182:183], v[182:183], 1.0 op_sel_hi:[1,0]
    v_pk_mul_f32 v[112:113], v[192:193], v[192:193]
    v_pk_mul_f32 v[114:115], v[194:195], v[194:195]
    v_pk_mul_f32 v[124:125], v[196:197], v[196:197]
    v_pk_mul_f32 v[126:127], v[198:199], v[198:199]
    v_pk_mul_f32 v[200:201], v[192:193], v[200:201]
    v_pk_mul_f32 v[202:203], v[194:195], v[202:203]
    v_pk_mul_f32 v[204:205], v[196:197], v[204:205]
    v_pk_mul_f32 v[206:207], v[198:199], v[206:207]
    v_pk_fma_f32 v[112:113], v[112:113], s[42:43], v[120:121]
    v_pk_fma_f32 v[114:115], v[114:115], s[42:43], v[120:121]
    v_pk_fma_f32 v[124:125], v[124:125], s[42:43], v[120:121]
    v_pk_fma_f32 v[126:127], v[126:127], s[42:43], v[120:121]
    v_pk_mul_f32 v[192:193], v[112:113], v[192:193]
    v_pk_mul_f32 v[194:195], v[114:115], v[194:195]
    v_pk_mul_f32 v[196:197], v[124:125], v[196:197]
    v_pk_mul_f32 v[198:199], v[126:127], v[198:199]
    v_mfma_f32_16x16x32_bf16 v[212:215], v[100:103], v[88:91], v[212:215]
    ds_read_b128 v[40:43], v116 offset:63488
    v_rcp_f32 v176, v176
    v_mfma_f32_16x16x32_bf16 v[216:219], v[104:107], v[88:91], v[216:219]
    ds_read_b128 v[44:47], v117 offset:63488
    v_rcp_f32 v177, v177
    v_mfma_f32_16x16x32_bf16 v[220:223], v[108:111], v[88:91], v[220:223]
    v_rcp_f32 v178, v178
    s_waitcnt lgkmcnt(6)
    v_mfma_f32_16x16x32_bf16 v[208:211], v[64:67], v[92:95], v[208:211]
    v_rcp_f32 v179, v179
    v_mfma_f32_16x16x32_bf16 v[212:215], v[68:71], v[92:95], v[212:215]
    v_rcp_f32 v180, v180
    v_mfma_f32_16x16x32_bf16 v[216:219], v[72:75], v[92:95], v[216:219]
    v_rcp_f32 v181, v181
    v_mfma_f32_16x16x32_bf16 v[220:223], v[76:79], v[92:95], v[220:223]
    v_rcp_f32 v182, v182
    s_waitcnt lgkmcnt(5)
    v_mfma_f32_16x16x32_bf16 v[224:227], v[48:51], v[32:35], v[224:227]
    v_rcp_f32 v183, v183
    v_mfma_f32_16x16x32_bf16 v[228:231], v[52:55], v[32:35], v[228:231]
    ds_read_b128 v[88:91], v116 offset:14336
    v_exp_f32 v192, v192
    v_mfma_f32_16x16x32_bf16 v[232:235], v[56:59], v[32:35], v[232:235]
    ds_read_b128 v[92:95], v117 offset:14336
    v_exp_f32 v193, v193
    v_mfma_f32_16x16x32_bf16 v[236:239], v[60:63], v[32:35], v[236:239]
    v_exp_f32 v194, v194
    s_waitcnt lgkmcnt(6)
    v_mfma_f32_16x16x32_bf16 v[224:227], v[16:19], v[36:39], v[224:227]
    v_exp_f32 v195, v195
    v_mfma_f32_16x16x32_bf16 v[228:231], v[20:23], v[36:39], v[228:231]
    v_exp_f32 v196, v196
    v_mfma_f32_16x16x32_bf16 v[232:235], v[24:27], v[36:39], v[232:235]
    v_exp_f32 v197, v197
    v_mfma_f32_16x16x32_bf16 v[236:239], v[28:31], v[36:39], v[236:239]
    v_exp_f32 v198, v198
    s_waitcnt lgkmcnt(5)
    v_mfma_f32_16x16x32_bf16 v[224:227], v[96:99], v[80:83], v[224:227]
    v_exp_f32 v199, v199
    v_mfma_f32_16x16x32_bf16 v[228:231], v[100:103], v[80:83], v[228:231]
    v_pk_mul_f32 v[176:177], v[176:177], v[184:185]
    v_pk_mul_f32 v[178:179], v[178:179], v[186:187]
    v_pk_mul_f32 v[180:181], v[180:181], v[188:189]
    v_pk_mul_f32 v[182:183], v[182:183], v[190:191]
    v_cvt_pk_bf16_f32 v176, v176, v177
    v_cvt_pk_bf16_f32 v177, v178, v179
    v_cvt_pk_bf16_f32 v178, v180, v181
    v_cvt_pk_bf16_f32 v179, v182, v183
    buffer_store_dwordx4 v[176:179], v1, s[24:27], s38 offen offset:3072 sc1
    v_pk_add_f32 v[192:193], v[192:193], 1.0 op_sel_hi:[1,0]
    v_pk_add_f32 v[194:195], v[194:195], 1.0 op_sel_hi:[1,0]
    v_pk_add_f32 v[196:197], v[196:197], 1.0 op_sel_hi:[1,0]
    v_pk_add_f32 v[198:199], v[198:199], 1.0 op_sel_hi:[1,0]
    v_pk_mul_f32 v[112:113], v[208:209], v[208:209]
    v_pk_mul_f32 v[114:115], v[210:211], v[210:211]
    v_pk_mul_f32 v[124:125], v[212:213], v[212:213]
    v_pk_mul_f32 v[126:127], v[214:215], v[214:215]
    v_pk_mul_f32 v[216:217], v[208:209], v[216:217]
    v_pk_mul_f32 v[218:219], v[210:211], v[218:219]
    v_pk_mul_f32 v[220:221], v[212:213], v[220:221]
    v_pk_mul_f32 v[222:223], v[214:215], v[222:223]
    v_pk_fma_f32 v[112:113], v[112:113], s[42:43], v[120:121]
    v_pk_fma_f32 v[114:115], v[114:115], s[42:43], v[120:121]
    v_pk_fma_f32 v[124:125], v[124:125], s[42:43], v[120:121]
    v_pk_fma_f32 v[126:127], v[126:127], s[42:43], v[120:121]
    v_pk_mul_f32 v[208:209], v[112:113], v[208:209]
    v_pk_mul_f32 v[210:211], v[114:115], v[210:211]
    v_pk_mul_f32 v[212:213], v[124:125], v[212:213]
    v_pk_mul_f32 v[214:215], v[126:127], v[214:215]
    v_mfma_f32_16x16x32_bf16 v[232:235], v[104:107], v[80:83], v[232:235]
    v_rcp_f32 v192, v192
    v_mfma_f32_16x16x32_bf16 v[236:239], v[108:111], v[80:83], v[236:239]
    v_rcp_f32 v193, v193
    s_waitcnt lgkmcnt(4)
    v_mfma_f32_16x16x32_bf16 v[224:227], v[64:67], v[84:87], v[224:227]
    v_rcp_f32 v194, v194
    v_mfma_f32_16x16x32_bf16 v[228:231], v[68:71], v[84:87], v[228:231]
    v_rcp_f32 v195, v195
    v_mfma_f32_16x16x32_bf16 v[232:235], v[72:75], v[84:87], v[232:235]
    v_rcp_f32 v196, v196
    v_mfma_f32_16x16x32_bf16 v[236:239], v[76:79], v[84:87], v[236:239]
    v_rcp_f32 v197, v197
    s_waitcnt lgkmcnt(3)
    v_mfma_f32_16x16x32_bf16 v[240:243], v[48:51], v[40:43], v[240:243]
    v_rcp_f32 v198, v198
    v_mfma_f32_16x16x32_bf16 v[244:247], v[52:55], v[40:43], v[244:247]
    v_rcp_f32 v199, v199
    v_mfma_f32_16x16x32_bf16 v[248:251], v[56:59], v[40:43], v[248:251]
    v_exp_f32 v208, v208
    v_mfma_f32_16x16x32_bf16 v[252:255], v[60:63], v[40:43], v[252:255]
    v_exp_f32 v209, v209
    s_waitcnt lgkmcnt(2)
    v_mfma_f32_16x16x32_bf16 v[240:243], v[16:19], v[44:47], v[240:243]
    v_exp_f32 v210, v210
    v_mfma_f32_16x16x32_bf16 v[244:247], v[20:23], v[44:47], v[244:247]
    v_exp_f32 v211, v211
    v_mfma_f32_16x16x32_bf16 v[248:251], v[24:27], v[44:47], v[248:251]
    v_exp_f32 v212, v212
    v_mfma_f32_16x16x32_bf16 v[252:255], v[28:31], v[44:47], v[252:255]
    v_exp_f32 v213, v213
    s_waitcnt lgkmcnt(1)
    v_mfma_f32_16x16x32_bf16 v[240:243], v[96:99], v[88:91], v[240:243]
    v_exp_f32 v214, v214
    v_mfma_f32_16x16x32_bf16 v[244:247], v[100:103], v[88:91], v[244:247]
    v_exp_f32 v215, v215
    v_mfma_f32_16x16x32_bf16 v[248:251], v[104:107], v[88:91], v[248:251]
    v_pk_mul_f32 v[192:193], v[192:193], v[200:201]
    v_pk_mul_f32 v[194:195], v[194:195], v[202:203]
    v_pk_mul_f32 v[196:197], v[196:197], v[204:205]
    v_pk_mul_f32 v[198:199], v[198:199], v[206:207]
    v_cvt_pk_bf16_f32 v192, v192, v193
    v_cvt_pk_bf16_f32 v193, v194, v195
    v_cvt_pk_bf16_f32 v194, v196, v197
    v_cvt_pk_bf16_f32 v195, v198, v199
    buffer_store_dwordx4 v[192:195], v1, s[24:27], s39 offen offset:0 sc1
    v_pk_add_f32 v[208:209], v[208:209], 1.0 op_sel_hi:[1,0]
    v_pk_add_f32 v[210:211], v[210:211], 1.0 op_sel_hi:[1,0]
    v_pk_add_f32 v[212:213], v[212:213], 1.0 op_sel_hi:[1,0]
    v_pk_add_f32 v[214:215], v[214:215], 1.0 op_sel_hi:[1,0]
    v_pk_mul_f32 v[112:113], v[224:225], v[224:225]
    v_pk_mul_f32 v[114:115], v[226:227], v[226:227]
    v_pk_mul_f32 v[124:125], v[228:229], v[228:229]
    v_pk_mul_f32 v[126:127], v[230:231], v[230:231]
    v_pk_mul_f32 v[232:233], v[224:225], v[232:233]
    v_pk_mul_f32 v[234:235], v[226:227], v[234:235]
    v_pk_mul_f32 v[236:237], v[228:229], v[236:237]
    v_pk_mul_f32 v[238:239], v[230:231], v[238:239]
    v_pk_fma_f32 v[112:113], v[112:113], s[42:43], v[120:121]
    v_pk_fma_f32 v[114:115], v[114:115], s[42:43], v[120:121]
    v_pk_fma_f32 v[124:125], v[124:125], s[42:43], v[120:121]
    v_pk_fma_f32 v[126:127], v[126:127], s[42:43], v[120:121]
    v_pk_mul_f32 v[224:225], v[112:113], v[224:225]
    v_pk_mul_f32 v[226:227], v[114:115], v[226:227]
    v_pk_mul_f32 v[228:229], v[124:125], v[228:229]
    v_pk_mul_f32 v[230:231], v[126:127], v[230:231]
    v_mfma_f32_16x16x32_bf16 v[252:255], v[108:111], v[88:91], v[252:255]
    v_rcp_f32 v208, v208
    s_waitcnt lgkmcnt(0)
    v_mfma_f32_16x16x32_bf16 v[240:243], v[64:67], v[92:95], v[240:243]
    v_rcp_f32 v209, v209
    v_mfma_f32_16x16x32_bf16 v[244:247], v[68:71], v[92:95], v[244:247]
    v_rcp_f32 v210, v210
    v_mfma_f32_16x16x32_bf16 v[248:251], v[72:75], v[92:95], v[248:251]
    v_rcp_f32 v211, v211
    v_mfma_f32_16x16x32_bf16 v[252:255], v[76:79], v[92:95], v[252:255]
    v_rcp_f32 v212, v212
    v_rcp_f32 v213, v213
    v_rcp_f32 v214, v214
    v_rcp_f32 v215, v215
    v_exp_f32 v224, v224
    v_exp_f32 v225, v225
    v_exp_f32 v226, v226
    v_exp_f32 v227, v227
    v_exp_f32 v228, v228
    v_exp_f32 v229, v229
    v_exp_f32 v230, v230
    v_exp_f32 v231, v231
    v_pk_mul_f32 v[208:209], v[208:209], v[216:217]
    v_pk_mul_f32 v[210:211], v[210:211], v[218:219]
    v_pk_mul_f32 v[212:213], v[212:213], v[220:221]
    v_pk_mul_f32 v[214:215], v[214:215], v[222:223]
    v_cvt_pk_bf16_f32 v208, v208, v209
    v_cvt_pk_bf16_f32 v209, v210, v211
    v_cvt_pk_bf16_f32 v210, v212, v213
    v_cvt_pk_bf16_f32 v211, v214, v215
    buffer_store_dwordx4 v[208:211], v1, s[24:27], s39 offen offset:1024 sc1
    v_pk_add_f32 v[224:225], v[224:225], 1.0 op_sel_hi:[1,0]
    v_pk_add_f32 v[226:227], v[226:227], 1.0 op_sel_hi:[1,0]
    v_pk_add_f32 v[228:229], v[228:229], 1.0 op_sel_hi:[1,0]
    v_pk_add_f32 v[230:231], v[230:231], 1.0 op_sel_hi:[1,0]
    v_pk_mul_f32 v[112:113], v[240:241], v[240:241]
    v_pk_mul_f32 v[114:115], v[242:243], v[242:243]
    v_pk_mul_f32 v[124:125], v[244:245], v[244:245]
    v_pk_mul_f32 v[126:127], v[246:247], v[246:247]
    v_pk_mul_f32 v[248:249], v[240:241], v[248:249]
    v_pk_mul_f32 v[250:251], v[242:243], v[250:251]
    v_pk_mul_f32 v[252:253], v[244:245], v[252:253]
    v_pk_mul_f32 v[254:255], v[246:247], v[254:255]
    v_pk_fma_f32 v[112:113], v[112:113], s[42:43], v[120:121]
    v_pk_fma_f32 v[114:115], v[114:115], s[42:43], v[120:121]
    v_pk_fma_f32 v[124:125], v[124:125], s[42:43], v[120:121]
    v_pk_fma_f32 v[126:127], v[126:127], s[42:43], v[120:121]
    v_pk_mul_f32 v[240:241], v[112:113], v[240:241]
    v_pk_mul_f32 v[242:243], v[114:115], v[242:243]
    v_pk_mul_f32 v[244:245], v[124:125], v[244:245]
    v_pk_mul_f32 v[246:247], v[126:127], v[246:247]
    v_rcp_f32 v224, v224
    v_rcp_f32 v225, v225
    v_rcp_f32 v226, v226
    v_rcp_f32 v227, v227
    v_rcp_f32 v228, v228
    v_rcp_f32 v229, v229
    v_rcp_f32 v230, v230
    v_rcp_f32 v231, v231
    v_exp_f32 v240, v240
    v_exp_f32 v241, v241
    v_exp_f32 v242, v242
    v_exp_f32 v243, v243
    v_exp_f32 v244, v244
    v_exp_f32 v245, v245
    v_exp_f32 v246, v246
    v_exp_f32 v247, v247
    v_pk_mul_f32 v[224:225], v[224:225], v[232:233]
    v_pk_mul_f32 v[226:227], v[226:227], v[234:235]
    v_pk_mul_f32 v[228:229], v[228:229], v[236:237]
    v_pk_mul_f32 v[230:231], v[230:231], v[238:239]
    v_cvt_pk_bf16_f32 v224, v224, v225
    v_cvt_pk_bf16_f32 v225, v226, v227
    v_cvt_pk_bf16_f32 v226, v228, v229
    v_cvt_pk_bf16_f32 v227, v230, v231
    buffer_store_dwordx4 v[224:227], v1, s[24:27], s39 offen offset:2048 sc1
    v_pk_add_f32 v[240:241], v[240:241], 1.0 op_sel_hi:[1,0]
    v_pk_add_f32 v[242:243], v[242:243], 1.0 op_sel_hi:[1,0]
    v_pk_add_f32 v[244:245], v[244:245], 1.0 op_sel_hi:[1,0]
    v_pk_add_f32 v[246:247], v[246:247], 1.0 op_sel_hi:[1,0]
    v_rcp_f32 v240, v240
    v_rcp_f32 v241, v241
    v_rcp_f32 v242, v242
    v_rcp_f32 v243, v243
    v_rcp_f32 v244, v244
    v_rcp_f32 v245, v245
    v_rcp_f32 v246, v246
    v_rcp_f32 v247, v247
    v_pk_mul_f32 v[240:241], v[240:241], v[248:249]
    v_pk_mul_f32 v[242:243], v[242:243], v[250:251]
    v_pk_mul_f32 v[244:245], v[244:245], v[252:253]
    v_pk_mul_f32 v[246:247], v[246:247], v[254:255]
    v_cvt_pk_bf16_f32 v240, v240, v241
    v_cvt_pk_bf16_f32 v241, v242, v243
    v_cvt_pk_bf16_f32 v242, v244, v245
    v_cvt_pk_bf16_f32 v243, v246, v247
    buffer_store_dwordx4 v[240:243], v1, s[24:27], s39 offen offset:3072 sc1
    s_waitcnt vmcnt(0)
    s_mov_b32 s78, 131072
L_NCB:
    v_readfirstlane_b32 s77, v15
    v_readfirstlane_b32 s76, v14
    s_cmp_lg_u32 s77, 0
    s_cbranch_scc1 L_NOKB
    buffer_load_dwordx2 v[14:15], off, s[64:67], 0 sc1
    s_waitcnt vmcnt(0)
    s_sub_u32 s78, s78, 1
    s_cbranch_scc0 L_NCB
L_NOKB:
    s_mov_b64 exec, 1
    buffer_store_dwordx2 v[14:15], off, s[60:63], s40 sc1
    s_mov_b64 exec, -1
L_BJOIN:
    s_barrier
    s_add_u32 m0, s74, 49152
    s_nop 0
    buffer_load_dwordx4 v2, s[52:55], s68 offen offset:0 lds
    buffer_load_dwordx4 v3, s[52:55], s68 offen offset:1024 lds
    buffer_load_dwordx4 v4, s[52:55], s68 offen offset:2048 lds
    buffer_load_dwordx4 v5, s[52:55], s68 offen offset:3072 lds
    s_add_u32 s68, s68, 65536
    s_add_u32 m0, s74, 65536
    s_nop 0
    buffer_load_dwordx4 v2, s[52:55], s68 offen offset:0 lds
    buffer_load_dwordx4 v3, s[52:55], s68 offen offset:1024 lds
    buffer_load_dwordx4 v4, s[52:55], s68 offen offset:2048 lds
    buffer_load_dwordx4 v5, s[52:55], s68 offen offset:3072 lds
    s_add_u32 s68, s68, 65536
    s_add_u32 m0, s74, 16384
    s_nop 0
    buffer_load_dwordx4 v2, s[52:55], s68 offen offset:0 lds
    buffer_load_dwordx4 v3, s[52:55], s68 offen offset:1024 lds
    buffer_load_dwordx4 v4, s[52:55], s68 offen offset:2048 lds
    buffer_load_dwordx4 v5, s[52:55], s68 offen offset:3072 lds
    s_add_u32 s68, s68, 65536
    s_add_u32 m0, s74, 0
    s_nop 0
    buffer_load_dwordx4 v2, s[52:55], s68 offen offset:0 lds
    buffer_load_dwordx4 v3, s[52:55], s68 offen offset:1024 lds
    buffer_load_dwordx4 v4, s[52:55], s68 offen offset:2048 lds
    buffer_load_dwordx4 v5, s[52:55], s68 offen offset:3072 lds
    s_add_u32 s68, s68, 65536
    s_add_u32 m0, s74, 32768
    s_nop 0
    buffer_load_dwordx4 v2, s[52:55], s68 offen offset:0 lds
    buffer_load_dwordx4 v3, s[52:55], s68 offen offset:1024 lds
    buffer_load_dwordx4 v4, s[52:55], s68 offen offset:2048 lds
    buffer_load_dwordx4 v5, s[52:55], s68 offen offset:3072 lds
    s_add_u32 s68, s68, 65536
    s_waitcnt vmcnt(16)
    ds_read_b64_tr_b16 v[48:49], v6 offset:49152
    ds_read_b64_tr_b16 v[50:51], v6 offset:51200
    ds_read_b64_tr_b16 v[52:53], v7 offset:49152
    ds_read_b64_tr_b16 v[54:55], v7 offset:51200
    ds_read_b64_tr_b16 v[56:57], v8 offset:49152
    ds_read_b64_tr_b16 v[58:59], v8 offset:51200
    ds_read_b64_tr_b16 v[60:61], v9 offset:49152
    ds_read_b64_tr_b16 v[62:63], v9 offset:51200
    s_waitcnt lgkmcnt(0)
    s_add_u32 m0, s74, 49152
    s_nop 0
    buffer_load_dwordx4 v2, s[52:55], s68 offen offset:0 lds
    buffer_load_dwordx4 v3, s[52:55], s68 offen offset:1024 lds
    buffer_load_dwordx4 v4, s[52:55], s68 offen offset:2048 lds
    buffer_load_dwordx4 v5, s[52:55], s68 offen offset:3072 lds
    s_add_u32 s68, s68, 65536
    s_waitcnt vmcnt(16)
    ds_read_b64_tr_b16 v[64:65], v10 offset:0
    ds_read_b64_tr_b16 v[66:67], v10 offset:2048
    ds_read_b64_tr_b16 v[68:69], v11 offset:0
    ds_read_b64_tr_b16 v[70:71], v11 offset:2048
    ds_read_b64_tr_b16 v[72:73], v12 offset:0
    ds_read_b64_tr_b16 v[74:75], v12 offset:2048
    ds_read_b64_tr_b16 v[76:77], v13 offset:0
    ds_read_b64_tr_b16 v[78:79], v13 offset:2048
    s_waitcnt lgkmcnt(0)
    s_add_u32 m0, s74, 65536
    s_nop 0
    buffer_load_dwordx4 v2, s[52:55], s68 offen offset:0 lds
    buffer_load_dwordx4 v3, s[52:55], s68 offen offset:1024 lds
    buffer_load_dwordx4 v4, s[52:55], s68 offen offset:2048 lds
    buffer_load_dwordx4 v5, s[52:55], s68 offen offset:3072 lds
    s_add_u32 s68, s68, 65536
    s_waitcnt vmcnt(16)
    ds_read_b64_tr_b16 v[80:81], v6 offset:16384
    ds_read_b64_tr_b16 v[82:83], v6 offset:18432
    ds_read_b64_tr_b16 v[84:85], v7 offset:16384
    ds_read_b64_tr_b16 v[86:87], v7 offset:18432
    ds_read_b64_tr_b16 v[88:89], v8 offset:16384
    ds_read_b64_tr_b16 v[90:91], v8 offset:18432
    ds_read_b64_tr_b16 v[92:93], v9 offset:16384
    ds_read_b64_tr_b16 v[94:95], v9 offset:18432
    s_waitcnt lgkmcnt(0)
    s_add_u32 m0, s74, 16384
    s_nop 0
    buffer_load_dwordx4 v2, s[52:55], s68 offen offset:0 lds
    buffer_load_dwordx4 v3, s[52:55], s68 offen offset:1024 lds
    buffer_load_dwordx4 v4, s[52:55], s68 offen offset:2048 lds
    buffer_load_dwordx4 v5, s[52:55], s68 offen offset:3072 lds
    s_add_u32 s68, s68, 65536
    s_waitcnt vmcnt(16)
    ds_read_b64_tr_b16 v[96:97], v6 offset:0
    ds_read_b64_tr_b16 v[98:99], v6 offset:2048
    ds_read_b64_tr_b16 v[100:101], v7 offset:0
    ds_read_b64_tr_b16 v[102:103], v7 offset:2048
    ds_read_b64_tr_b16 v[104:105], v8 offset:0
    ds_read_b64_tr_b16 v[106:107], v8 offset:2048
    ds_read_b64_tr_b16 v[108:109], v9 offset:0
    ds_read_b64_tr_b16 v[110:111], v9 offset:2048
    s_waitcnt lgkmcnt(0)
    s_add_u32 m0, s74, 0
    s_nop 0
    buffer_load_dwordx4 v2, s[52:55], s68 offen offset:0 lds
    buffer_load_dwordx4 v3, s[52:55], s68 offen offset:1024 lds
    buffer_load_dwordx4 v4, s[52:55], s68 offen offset:2048 lds
    buffer_load_dwordx4 v5, s[52:55], s68 offen offset:3072 lds
    s_add_u32 s68, s68, 65536
    s_waitcnt vmcnt(16)
    ds_read_b64_tr_b16 v[112:113], v6 offset:32768
    ds_read_b64_tr_b16 v[114:115], v6 offset:34816
    ds_read_b64_tr_b16 v[116:117], v7 offset:32768
    ds_read_b64_tr_b16 v[118:119], v7 offset:34816
    ds_read_b64_tr_b16 v[120:121], v8 offset:32768
    ds_read_b64_tr_b16 v[122:123], v8 offset:34816
    ds_read_b64_tr_b16 v[124:125], v9 offset:32768
    ds_read_b64_tr_b16 v[126:127], v9 offset:34816
    s_waitcnt lgkmcnt(0)
    s_add_u32 m0, s74, 32768
    s_nop 0
    buffer_load_dwordx4 v2, s[52:55], s68 offen offset:0 lds
    buffer_load_dwordx4 v3, s[52:55], s68 offen offset:1024 lds
    buffer_load_dwordx4 v4, s[52:55], s68 offen offset:2048 lds
    buffer_load_dwordx4 v5, s[52:55], s68 offen offset:3072 lds
    s_add_u32 s68, s68, 65536
    s_waitcnt vmcnt(16)
    ds_read_b64_tr_b16 v[128:129], v6 offset:49152
    ds_read_b64_tr_b16 v[130:131], v6 offset:51200
    ds_read_b64_tr_b16 v[132:133], v7 offset:49152
    ds_read_b64_tr_b16 v[134:135], v7 offset:51200
    ds_read_b64_tr_b16 v[136:137], v8 offset:49152
    ds_read_b64_tr_b16 v[138:139], v8 offset:51200
    ds_read_b64_tr_b16 v[140:141], v9 offset:49152
    ds_read_b64_tr_b16 v[142:143], v9 offset:51200
    s_waitcnt lgkmcnt(0)
    s_add_u32 m0, s74, 49152
    s_nop 0
    buffer_load_dwordx4 v2, s[52:55], s68 offen offset:0 lds
    buffer_load_dwordx4 v3, s[52:55], s68 offen offset:1024 lds
    buffer_load_dwordx4 v4, s[52:55], s68 offen offset:2048 lds
    buffer_load_dwordx4 v5, s[52:55], s68 offen offset:3072 lds
    s_add_u32 s68, s68, 65536
    s_waitcnt vmcnt(16)
    ds_read_b64_tr_b16 v[144:145], v10 offset:0
    ds_read_b64_tr_b16 v[146:147], v10 offset:2048
    ds_read_b64_tr_b16 v[148:149], v11 offset:0
    ds_read_b64_tr_b16 v[150:151], v11 offset:2048
    ds_read_b64_tr_b16 v[152:153], v12 offset:0
    ds_read_b64_tr_b16 v[154:155], v12 offset:2048
    ds_read_b64_tr_b16 v[156:157], v13 offset:0
    ds_read_b64_tr_b16 v[158:159], v13 offset:2048
    s_waitcnt lgkmcnt(0)
    s_lshr_b32 s79, s50, 1
    s_lshl_b32 s79, s79, 3
    s_xor_b32 s75, s3, 4
    s_add_u32 s79, s79, s75
    s_lshl_b32 s79, s79, 7
    v_min_u32 v192, 13, v0
    v_lshlrev_b32 v192, 3, v192
    buffer_load_dwordx2 v[194:195], v192, s[60:63], s79 offen sc1
    s_add_u32 m0, s74, 65536
    s_nop 0
    buffer_load_dwordx4 v2, s[52:55], s68 offen offset:0 lds
    buffer_load_dwordx4 v3, s[52:55], s68 offen offset:1024 lds
    buffer_load_dwordx4 v4, s[52:55], s68 offen offset:2048 lds
    buffer_load_dwordx4 v5, s[52:55], s68 offen offset:3072 lds
    s_add_u32 s68, s68, 65536
    s_waitcnt vmcnt(17)
    ds_read_b64_tr_b16 v[160:161], v6 offset:16384
    ds_read_b64_tr_b16 v[162:163], v6 offset:18432
    ds_read_b64_tr_b16 v[164:165], v7 offset:16384
    ds_read_b64_tr_b16 v[166:167], v7 offset:18432
    ds_read_b64_tr_b16 v[168:169], v8 offset:16384
    ds_read_b64_tr_b16 v[170:171], v8 offset:18432
    ds_read_b64_tr_b16 v[172:173], v9 offset:16384
    ds_read_b64_tr_b16 v[174:175], v9 offset:18432
    s_waitcnt lgkmcnt(0)
    s_add_u32 m0, s74, 16384
    s_nop 0
    buffer_load_dwordx4 v2, s[52:55], s68 offen offset:0 lds
    buffer_load_dwordx4 v3, s[52:55], s68 offen offset:1024 lds
    buffer_load_dwordx4 v4, s[52:55], s68 offen offset:2048 lds
    buffer_load_dwordx4 v5, s[52:55], s68 offen offset:3072 lds
    s_add_u32 s68, s68, 65536
    s_waitcnt vmcnt(17)
    ds_read_b64_tr_b16 v[176:177], v6 offset:0
    ds_read_b64_tr_b16 v[178:179], v6 offset:2048
    ds_read_b64_tr_b16 v[180:181], v7 offset:0
    ds_read_b64_tr_b16 v[182:183], v7 offset:2048
    ds_read_b64_tr_b16 v[184:185], v8 offset:0
    ds_read_b64_tr_b16 v[186:187], v8 offset:2048
    ds_read_b64_tr_b16 v[188:189], v9 offset:0
    ds_read_b64_tr_b16 v[190:191], v9 offset:2048
    s_waitcnt lgkmcnt(0)
    s_add_u32 m0, s74, 0
    s_nop 0
    buffer_load_dwordx4 v2, s[52:55], s68 offen offset:0 lds
    buffer_load_dwordx4 v3, s[52:55], s68 offen offset:1024 lds
    buffer_load_dwordx4 v4, s[52:55], s68 offen offset:2048 lds
    buffer_load_dwordx4 v5, s[52:55], s68 offen offset:3072 lds
    s_add_u32 s68, s68, 65536
    s_mov_b32 s78, 131072
L_NCE:
    v_readfirstlane_b32 s77, v15
    v_readfirstlane_b32 s76, v14
    s_cmp_lg_u32 s77, 0
    s_cbranch_scc1 L_NOKE
    buffer_load_dwordx2 v[14:15], off, s[64:67], 0 sc1
    s_waitcnt vmcnt(0)
    s_sub_u32 s78, s78, 1
    s_cbranch_scc0 L_NCE
L_NOKE:
    s_waitcnt vmcnt(12)
    v_cmp_ne_u64 vcc, s[76:77], v[194:195]
    s_cbranch_vccz L_GO
L_WDONE:
    s_mov_b32 s78, 131072
L_NCP:
    v_readfirstlane_b32 s77, v15
    v_readfirstlane_b32 s76, v14
    s_cmp_lg_u32 s77, 0
    s_cbranch_scc1 L_NOKP
    buffer_load_dwordx2 v[14:15], off, s[64:67], 0 sc1
    s_waitcnt vmcnt(0)
    s_sub_u32 s78, s78, 1
    s_cbranch_scc0 L_NCP
L_NOKP:
    s_lshr_b32 s79, s50, 1
    s_lshl_b32 s79, s79, 3
    s_xor_b32 s75, s3, 4
    s_add_u32 s79, s79, s75
    s_lshl_b32 s79, s79, 7
    v_min_u32 v192, 13, v0
    v_lshlrev_b32 v192, 3, v192
    s_mov_b32 s78, 131072
L_POLL:
    buffer_load_dwordx2 v[14:15], v192, s[60:63], s79 offen sc1
    s_waitcnt vmcnt(0)
    v_cmp_ne_u64 vcc, s[76:77], v[14:15]
    s_cbranch_vccz L_GO
    s_sub_u32 s78, s78, 1
    s_cbranch_scc0 L_POLL
L_GO:
    buffer_load_dwordx4 v[16:19], v1, s[24:27], s72 offen offset:0 sc1
    buffer_load_dwordx4 v[20:23], v1, s[24:27], s72 offen offset:1024 sc1
    buffer_load_dwordx4 v[24:27], v1, s[24:27], s72 offen offset:2048 sc1
    buffer_load_dwordx4 v[28:31], v1, s[24:27], s72 offen offset:3072 sc1
    s_add_u32 s72, s72, 4096
    buffer_load_dwordx4 v[32:35], v1, s[24:27], s72 offen offset:0 sc1
    buffer_load_dwordx4 v[36:39], v1, s[24:27], s72 offen offset:1024 sc1
    buffer_load_dwordx4 v[40:43], v1, s[24:27], s72 offen offset:2048 sc1
    buffer_load_dwordx4 v[44:47], v1, s[24:27], s72 offen offset:3072 sc1
    s_add_u32 s72, s72, 4096
    s_waitcnt vmcnt(7)
    v_mfma_f32_16x16x32_bf16 v[192:195], v[48:51], v[16:19], 0
    v_mfma_f32_16x16x32_bf16 v[196:199], v[52:55], v[16:19], 0
    v_mfma_f32_16x16x32_bf16 v[200:203], v[56:59], v[16:19], 0
    v_mfma_f32_16x16x32_bf16 v[204:207], v[60:63], v[16:19], 0
    buffer_load_dwordx4 v[16:19], v1, s[24:27], s72 offen offset:0 sc1
    s_waitcnt vmcnt(7)
    v_mfma_f32_16x16x32_bf16 v[208:211], v[48:51], v[20:23], 0
    v_mfma_f32_16x16x32_bf16 v[212:215], v[52:55], v[20:23], 0
    v_mfma_f32_16x16x32_bf16 v[216:219], v[56:59], v[20:23], 0
    v_mfma_f32_16x16x32_bf16 v[220:223], v[60:63], v[20:23], 0
    buffer_load_dwordx4 v[20:23], v1, s[24:27], s72 offen offset:1024 sc1
    s_waitcnt vmcnt(7)
    v_mfma_f32_16x16x32_bf16 v[224:227], v[48:51], v[24:27], 0
    v_mfma_f32_16x16x32_bf16 v[228:231], v[52:55], v[24:27], 0
    v_mfma_f32_16x16x32_bf16 v[232:235], v[56:59], v[24:27], 0
    v_mfma_f32_16x16x32_bf16 v[236:239], v[60:63], v[24:27], 0
    buffer_load_dwordx4 v[24:27], v1, s[24:27], s72 offen offset:2048 sc1
    s_waitcnt vmcnt(7)
    v_mfma_f32_16x16x32_bf16 v[240:243], v[48:51], v[28:31], 0
    v_mfma_f32_16x16x32_bf16 v[244:247], v[52:55], v[28:31], 0
    v_mfma_f32_16x16x32_bf16 v[248:251], v[56:59], v[28:31], 0
    v_mfma_f32_16x16x32_bf16 v[252:255], v[60:63], v[28:31], 0
    buffer_load_dwordx4 v[28:31], v1, s[24:27], s72 offen offset:3072 sc1
    s_add_u32 s72, s72, 4096
    s_waitcnt vmcnt(7)
    v_mfma_f32_16x16x32_bf16 v[192:195], v[64:67], v[32:35], v[192:195]
    buffer_load_dwordx4 v[48:51], v1, s[24:27], s72 offen offset:0 sc1
    v_mfma_f32_16x16x32_bf16 v[196:199], v[68:71], v[32:35], v[196:199]
    buffer_load_dwordx4 v[52:55], v1, s[24:27], s72 offen offset:1024 sc1
    v_mfma_f32_16x16x32_bf16 v[200:203], v[72:75], v[32:35], v[200:203]
    buffer_load_dwordx4 v[56:59], v1, s[24:27], s72 offen offset:2048 sc1
    v_mfma_f32_16x16x32_bf16 v[204:207], v[76:79], v[32:35], v[204:207]
    buffer_load_dwordx4 v[60:63], v1, s[24:27], s72 offen offset:3072 sc1
    s_add_u32 s72, s72, 4096
    buffer_load_dwordx4 v[32:35], v1, s[24:27], s72 offen offset:0 sc1
    s_waitcnt vmcnt(11)
    v_mfma_f32_16x16x32_bf16 v[208:211], v[64:67], v[36:39], v[208:211]
    v_mfma_f32_16x16x32_bf16 v[212:215], v[68:71], v[36:39], v[212:215]
    v_mfma_f32_16x16x32_bf16 v[216:219], v[72:75], v[36:39], v[216:219]
    v_mfma_f32_16x16x32_bf16 v[220:223], v[76:79], v[36:39], v[220:223]
    buffer_load_dwordx4 v[36:39], v1, s[24:27], s72 offen offset:1024 sc1
    s_waitcnt vmcnt(11)
    v_mfma_f32_16x16x32_bf16 v[224:227], v[64:67], v[40:43], v[224:227]
    v_mfma_f32_16x16x32_bf16 v[228:231], v[68:71], v[40:43], v[228:231]
    v_mfma_f32_16x16x32_bf16 v[232:235], v[72:75], v[40:43], v[232:235]
    v_mfma_f32_16x16x32_bf16 v[236:239], v[76:79], v[40:43], v[236:239]
    buffer_load_dwordx4 v[40:43], v1, s[24:27], s72 offen offset:2048 sc1
    s_waitcnt vmcnt(11)
    v_mfma_f32_16x16x32_bf16 v[240:243], v[64:67], v[44:47], v[240:243]
    v_mfma_f32_16x16x32_bf16 v[244:247], v[68:71], v[44:47], v[244:247]
    v_mfma_f32_16x16x32_bf16 v[248:251], v[72:75], v[44:47], v[248:251]
    v_mfma_f32_16x16x32_bf16 v[252:255], v[76:79], v[44:47], v[252:255]
    buffer_load_dwordx4 v[44:47], v1, s[24:27], s72 offen offset:3072 sc1
    s_add_u32 s72, s72, 4096
    s_waitcnt vmcnt(11)
    v_mfma_f32_16x16x32_bf16 v[192:195], v[80:83], v[16:19], v[192:195]
    v_mfma_f32_16x16x32_bf16 v[196:199], v[84:87], v[16:19], v[196:199]
    v_mfma_f32_16x16x32_bf16 v[200:203], v[88:91], v[16:19], v[200:203]
    v_mfma_f32_16x16x32_bf16 v[204:207], v[92:95], v[16:19], v[204:207]
    buffer_load_dwordx4 v[16:19], v1, s[24:27], s72 offen offset:0 sc1
    s_waitcnt vmcnt(11)
    v_mfma_f32_16x16x32_bf16 v[208:211], v[80:83], v[20:23], v[208:211]
    v_mfma_f32_16x16x32_bf16 v[212:215], v[84:87], v[20:23], v[212:215]
    v_mfma_f32_16x16x32_bf16 v[216:219], v[88:91], v[20:23], v[216:219]
    v_mfma_f32_16x16x32_bf16 v[220:223], v[92:95], v[20:23], v[220:223]
    buffer_load_dwordx4 v[20:23], v1, s[24:27], s72 offen offset:1024 sc1
    s_waitcnt vmcnt(11)
    v_mfma_f32_16x16x32_bf16 v[224:227], v[80:83], v[24:27], v[224:227]
    v_mfma_f32_16x16x32_bf16 v[228:231], v[84:87], v[24:27], v[228:231]
    v_mfma_f32_16x16x32_bf16 v[232:235], v[88:91], v[24:27], v[232:235]
    v_mfma_f32_16x16x32_bf16 v[236:239], v[92:95], v[24:27], v[236:239]
    buffer_load_dwordx4 v[24:27], v1, s[24:27], s72 offen offset:2048 sc1
    s_waitcnt vmcnt(11)
    v_mfma_f32_16x16x32_bf16 v[240:243], v[80:83], v[28:31], v[240:243]
    v_mfma_f32_16x16x32_bf16 v[244:247], v[84:87], v[28:31], v[244:247]
    v_mfma_f32_16x16x32_bf16 v[248:251], v[88:91], v[28:31], v[248:251]
    v_mfma_f32_16x16x32_bf16 v[252:255], v[92:95], v[28:31], v[252:255]
    buffer_load_dwordx4 v[28:31], v1, s[24:27], s72 offen offset:3072 sc1
    s_add_u32 s72, s72, 4096
    s_waitcnt vmcnt(11)
    v_mfma_f32_16x16x32_bf16 v[192:195], v[96:99], v[48:51], v[192:195]
    v_mfma_f32_16x16x32_bf16 v[196:199], v[100:103], v[48:51], v[196:199]
    v_mfma_f32_16x16x32_bf16 v[200:203], v[104:107], v[48:51], v[200:203]
    v_mfma_f32_16x16x32_bf16 v[204:207], v[108:111], v[48:51], v[204:207]
    buffer_load_dwordx4 v[48:51], v1, s[24:27], s72 offen offset:0 sc1
    s_waitcnt vmcnt(11)
    v_mfma_f32_16x16x32_bf16 v[208:211], v[96:99], v[52:55], v[208:211]
    v_mfma_f32_16x16x32_bf16 v[212:215], v[100:103], v[52:55], v[212:215]
    v_mfma_f32_16x16x32_bf16 v[216:219], v[104:107], v[52:55], v[216:219]
    v_mfma_f32_16x16x32_bf16 v[220:223], v[108:111], v[52:55], v[220:223]
    buffer_load_dwordx4 v[52:55], v1, s[24:27], s72 offen offset:1024 sc1
    s_waitcnt vmcnt(11)
    v_mfma_f32_16x16x32_bf16 v[224:227], v[96:99], v[56:59], v[224:227]
    v_mfma_f32_16x16x32_bf16 v[228:231], v[100:103], v[56:59], v[228:231]
    v_mfma_f32_16x16x32_bf16 v[232:235], v[104:107], v[56:59], v[232:235]
    v_mfma_f32_16x16x32_bf16 v[236:239], v[108:111], v[56:59], v[236:239]
    buffer_load_dwordx4 v[56:59], v1, s[24:27], s72 offen offset:2048 sc1
    s_waitcnt vmcnt(11)
    v_mfma_f32_16x16x32_bf16 v[240:243], v[96:99], v[60:63], v[240:243]
    v_mfma_f32_16x16x32_bf16 v[244:247], v[100:103], v[60:63], v[244:247]
    v_mfma_f32_16x16x32_bf16 v[248:251], v[104:107], v[60:63], v[248:251]
    v_mfma_f32_16x16x32_bf16 v[252:255], v[108:111], v[60:63], v[252:255]
    buffer_load_dwordx4 v[60:63], v1, s[24:27], s72 offen offset:3072 sc1
    s_add_u32 s72, s72, 4096
    s_waitcnt vmcnt(11)
    v_mfma_f32_16x16x32_bf16 v[192:195], v[112:115], v[32:35], v[192:195]
    v_mfma_f32_16x16x32_bf16 v[196:199], v[116:119], v[32:35], v[196:199]
    v_mfma_f32_16x16x32_bf16 v[200:203], v[120:123], v[32:35], v[200:203]
    v_mfma_f32_16x16x32_bf16 v[204:207], v[124:127], v[32:35], v[204:207]
    buffer_load_dwordx4 v[32:35], v1, s[24:27], s72 offen offset:0 sc1
    s_waitcnt vmcnt(11)
    v_mfma_f32_16x16x32_bf16 v[208:211], v[112:115], v[36:39], v[208:211]
    v_mfma_f32_16x16x32_bf16 v[212:215], v[116:119], v[36:39], v[212:215]
    v_mfma_f32_16x16x32_bf16 v[216:219], v[120:123], v[36:39], v[216:219]
    v_mfma_f32_16x16x32_bf16 v[220:223], v[124:127], v[36:39], v[220:223]
    buffer_load_dwordx4 v[36:39], v1, s[24:27], s72 offen offset:1024 sc1
    s_waitcnt vmcnt(11)
    v_mfma_f32_16x16x32_bf16 v[224:227], v[112:115], v[40:43], v[224:227]
    v_mfma_f32_16x16x32_bf16 v[228:231], v[116:119], v[40:43], v[228:231]
    v_mfma_f32_16x16x32_bf16 v[232:235], v[120:123], v[40:43], v[232:235]
    v_mfma_f32_16x16x32_bf16 v[236:239], v[124:127], v[40:43], v[236:239]
    buffer_load_dwordx4 v[40:43], v1, s[24:27], s72 offen offset:2048 sc1
    s_waitcnt vmcnt(11)
    v_mfma_f32_16x16x32_bf16 v[240:243], v[112:115], v[44:47], v[240:243]
    v_mfma_f32_16x16x32_bf16 v[244:247], v[116:119], v[44:47], v[244:247]
    v_mfma_f32_16x16x32_bf16 v[248:251], v[120:123], v[44:47], v[248:251]
    v_mfma_f32_16x16x32_bf16 v[252:255], v[124:127], v[44:47], v[252:255]
    buffer_load_dwordx4 v[44:47], v1, s[24:27], s72 offen offset:3072 sc1
    s_add_u32 s72, s72, 4096
    s_waitcnt vmcnt(11)
    v_mfma_f32_16x16x32_bf16 v[192:195], v[128:131], v[16:19], v[192:195]
    v_mfma_f32_16x16x32_bf16 v[196:199], v[132:135], v[16:19], v[196:199]
    v_mfma_f32_16x16x32_bf16 v[200:203], v[136:139], v[16:19], v[200:203]
    v_mfma_f32_16x16x32_bf16 v[204:207], v[140:143], v[16:19], v[204:207]
    buffer_load_dwordx4 v[16:19], v1, s[24:27], s72 offen offset:0 sc1
    s_waitcnt vmcnt(11)
    v_mfma_f32_16x16x32_bf16 v[208:211], v[128:131], v[20:23], v[208:211]
    v_mfma_f32_16x16x32_bf16 v[212:215], v[132:135], v[20:23], v[212:215]
    v_mfma_f32_16x16x32_bf16 v[216:219], v[136:139], v[20:23], v[216:219]
    v_mfma_f32_16x16x32_bf16 v[220:223], v[140:143], v[20:23], v[220:223]
    buffer_load_dwordx4 v[20:23], v1, s[24:27], s72 offen offset:1024 sc1
    s_waitcnt vmcnt(11)
    v_mfma_f32_16x16x32_bf16 v[224:227], v[128:131], v[24:27], v[224:227]
    v_mfma_f32_16x16x32_bf16 v[228:231], v[132:135], v[24:27], v[228:231]
    v_mfma_f32_16x16x32_bf16 v[232:235], v[136:139], v[24:27], v[232:235]
    v_mfma_f32_16x16x32_bf16 v[236:239], v[140:143], v[24:27], v[236:239]
    buffer_load_dwordx4 v[24:27], v1, s[24:27], s72 offen offset:2048 sc1
    s_waitcnt vmcnt(11)
    v_mfma_f32_16x16x32_bf16 v[240:243], v[128:131], v[28:31], v[240:243]
    v_mfma_f32_16x16x32_bf16 v[244:247], v[132:135], v[28:31], v[244:247]
    v_mfma_f32_16x16x32_bf16 v[248:251], v[136:139], v[28:31], v[248:251]
    v_mfma_f32_16x16x32_bf16 v[252:255], v[140:143], v[28:31], v[252:255]
    buffer_load_dwordx4 v[28:31], v1, s[24:27], s72 offen offset:3072 sc1
    s_add_u32 s72, s72, 4096
    s_waitcnt vmcnt(11)
    v_mfma_f32_16x16x32_bf16 v[192:195], v[144:147], v[48:51], v[192:195]
    v_mfma_f32_16x16x32_bf16 v[196:199], v[148:151], v[48:51], v[196:199]
    v_mfma_f32_16x16x32_bf16 v[200:203], v[152:155], v[48:51], v[200:203]
    v_mfma_f32_16x16x32_bf16 v[204:207], v[156:159], v[48:51], v[204:207]
    buffer_load_dwordx4 v[48:51], v1, s[24:27], s72 offen offset:0 sc1
    s_waitcnt vmcnt(11)
    v_mfma_f32_16x16x32_bf16 v[208:211], v[144:147], v[52:55], v[208:211]
    v_mfma_f32_16x16x32_bf16 v[212:215], v[148:151], v[52:55], v[212:215]
    v_mfma_f32_16x16x32_bf16 v[216:219], v[152:155], v[52:55], v[216:219]
    v_mfma_f32_16x16x32_bf16 v[220:223], v[156:159], v[52:55], v[220:223]
    buffer_load_dwordx4 v[52:55], v1, s[24:27], s72 offen offset:1024 sc1
    s_waitcnt vmcnt(11)
    v_mfma_f32_16x16x32_bf16 v[224:227], v[144:147], v[56:59], v[224:227]
    v_mfma_f32_16x16x32_bf16 v[228:231], v[148:151], v[56:59], v[228:231]
    v_mfma_f32_16x16x32_bf16 v[232:235], v[152:155], v[56:59], v[232:235]
    v_mfma_f32_16x16x32_bf16 v[236:239], v[156:159], v[56:59], v[236:239]
    buffer_load_dwordx4 v[56:59], v1, s[24:27], s72 offen offset:2048 sc1
    s_waitcnt vmcnt(11)
    v_mfma_f32_16x16x32_bf16 v[240:243], v[144:147], v[60:63], v[240:243]
    v_mfma_f32_16x16x32_bf16 v[244:247], v[148:151], v[60:63], v[244:247]
    v_mfma_f32_16x16x32_bf16 v[248:251], v[152:155], v[60:63], v[248:251]
    v_mfma_f32_16x16x32_bf16 v[252:255], v[156:159], v[60:63], v[252:255]
    buffer_load_dwordx4 v[60:63], v1, s[24:27], s72 offen offset:3072 sc1
    s_add_u32 s72, s72, 4096
    s_waitcnt vmcnt(11)
    v_mfma_f32_16x16x32_bf16 v[192:195], v[160:163], v[32:35], v[192:195]
    v_mfma_f32_16x16x32_bf16 v[196:199], v[164:167], v[32:35], v[196:199]
    v_mfma_f32_16x16x32_bf16 v[200:203], v[168:171], v[32:35], v[200:203]
    v_mfma_f32_16x16x32_bf16 v[204:207], v[172:175], v[32:35], v[204:207]
    buffer_load_dwordx4 v[32:35], v1, s[24:27], s72 offen offset:0 sc1
    s_waitcnt vmcnt(11)
    v_mfma_f32_16x16x32_bf16 v[208:211], v[160:163], v[36:39], v[208:211]
    v_mfma_f32_16x16x32_bf16 v[212:215], v[164:167], v[36:39], v[212:215]
    v_mfma_f32_16x16x32_bf16 v[216:219], v[168:171], v[36:39], v[216:219]
    v_mfma_f32_16x16x32_bf16 v[220:223], v[172:175], v[36:39], v[220:223]
    buffer_load_dwordx4 v[36:39], v1, s[24:27], s72 offen offset:1024 sc1
    s_waitcnt vmcnt(11)
    v_mfma_f32_16x16x32_bf16 v[224:227], v[160:163], v[40:43], v[224:227]
    v_mfma_f32_16x16x32_bf16 v[228:231], v[164:167], v[40:43], v[228:231]
    v_mfma_f32_16x16x32_bf16 v[232:235], v[168:171], v[40:43], v[232:235]
    v_mfma_f32_16x16x32_bf16 v[236:239], v[172:175], v[40:43], v[236:239]
    buffer_load_dwordx4 v[40:43], v1, s[24:27], s72 offen offset:2048 sc1
    s_waitcnt vmcnt(11)
    v_mfma_f32_16x16x32_bf16 v[240:243], v[160:163], v[44:47], v[240:243]
    v_mfma_f32_16x16x32_bf16 v[244:247], v[164:167], v[44:47], v[244:247]
    v_mfma_f32_16x16x32_bf16 v[248:251], v[168:171], v[44:47], v[248:251]
    v_mfma_f32_16x16x32_bf16 v[252:255], v[172:175], v[44:47], v[252:255]
    buffer_load_dwordx4 v[44:47], v1, s[24:27], s72 offen offset:3072 sc1
    s_add_u32 s72, s72, 4096
    s_waitcnt vmcnt(11)
    v_mfma_f32_16x16x32_bf16 v[192:195], v[176:179], v[16:19], v[192:195]
    v_mfma_f32_16x16x32_bf16 v[196:199], v[180:183], v[16:19], v[196:199]
    v_mfma_f32_16x16x32_bf16 v[200:203], v[184:187], v[16:19], v[200:203]
    v_mfma_f32_16x16x32_bf16 v[204:207], v[188:191], v[16:19], v[204:207]
    buffer_load_dwordx4 v[16:19], v1, s[24:27], s72 offen offset:0 sc1
    s_waitcnt vmcnt(11)
    v_mfma_f32_16x16x32_bf16 v[208:211], v[176:179], v[20:23], v[208:211]
    ds_read_b64_tr_b16 v[64:65], v6 offset:32768
    v_mfma_f32_16x16x32_bf16 v[212:215], v[180:183], v[20:23], v[212:215]
    ds_read_b64_tr_b16 v[66:67], v6 offset:34816
    v_mfma_f32_16x16x32_bf16 v[216:219], v[184:187], v[20:23], v[216:219]
    ds_read_b64_tr_b16 v[68:69], v7 offset:32768
    v_mfma_f32_16x16x32_bf16 v[220:223], v[188:191], v[20:23], v[220:223]
    ds_read_b64_tr_b16 v[70:71], v7 offset:34816
    buffer_load_dwordx4 v[20:23], v1, s[24:27], s72 offen offset:1024 sc1
    s_waitcnt vmcnt(11)
    v_mfma_f32_16x16x32_bf16 v[224:227], v[176:179], v[24:27], v[224:227]
    ds_read_b64_tr_b16 v[72:73], v8 offset:32768
    v_mfma_f32_16x16x32_bf16 v[228:231], v[180:183], v[24:27], v[228:231]
    ds_read_b64_tr_b16 v[74:75], v8 offset:34816
    v_mfma_f32_16x16x32_bf16 v[232:235], v[184:187], v[24:27], v[232:235]
    ds_read_b64_tr_b16 v[76:77], v9 offset:32768
    v_mfma_f32_16x16x32_bf16 v[236:239], v[188:191], v[24:27], v[236:239]
    ds_read_b64_tr_b16 v[78:79], v9 offset:34816
    buffer_load_dwordx4 v[24:27], v1, s[24:27], s72 offen offset:2048 sc1
    s_waitcnt vmcnt(11)
    v_mfma_f32_16x16x32_bf16 v[240:243], v[176:179], v[28:31], v[240:243]
    v_mfma_f32_16x16x32_bf16 v[244:247], v[180:183], v[28:31], v[244:247]
    v_mfma_f32_16x16x32_bf16 v[248:251], v[184:187], v[28:31], v[248:251]
    v_mfma_f32_16x16x32_bf16 v[252:255], v[188:191], v[28:31], v[252:255]
    buffer_load_dwordx4 v[28:31], v1, s[24:27], s72 offen offset:3072 sc1
    s_add_u32 s72, s72, 4096
    s_waitcnt lgkmcnt(0)
    s_waitcnt vmcnt(11)
    v_mfma_f32_16x16x32_bf16 v[192:195], v[64:67], v[48:51], v[192:195]
    v_mfma_f32_16x16x32_bf16 v[196:199], v[68:71], v[48:51], v[196:199]
    v_mfma_f32_16x16x32_bf16 v[200:203], v[72:75], v[48:51], v[200:203]
    v_mfma_f32_16x16x32_bf16 v[204:207], v[76:79], v[48:51], v[204:207]
    s_add_u32 s73, s72, 4096
    buffer_load_dwordx4 v[48:51], v1, s[24:27], s72 offen offset:0 sc1
    s_waitcnt vmcnt(11)
    v_mfma_f32_16x16x32_bf16 v[208:211], v[64:67], v[52:55], v[208:211]
    ds_read_b64_tr_b16 v[80:81], v6 offset:49152
    v_mfma_f32_16x16x32_bf16 v[212:215], v[68:71], v[52:55], v[212:215]
    ds_read_b64_tr_b16 v[82:83], v6 offset:51200
    v_mfma_f32_16x16x32_bf16 v[216:219], v[72:75], v[52:55], v[216:219]
    ds_read_b64_tr_b16 v[84:85], v7 offset:49152
    v_mfma_f32_16x16x32_bf16 v[220:223], v[76:79], v[52:55], v[220:223]
    ds_read_b64_tr_b16 v[86:87], v7 offset:51200
    buffer_load_dwordx4 v[52:55], v1, s[24:27], s73 offen offset:0 sc1
    s_waitcnt vmcnt(11)
    v_mfma_f32_16x16x32_bf16 v[224:227], v[64:67], v[56:59], v[224:227]
    ds_read_b64_tr_b16 v[88:89], v8 offset:49152
    v_mfma_f32_16x16x32_bf16 v[228:231], v[68:71], v[56:59], v[228:231]
    ds_read_b64_tr_b16 v[90:91], v8 offset:51200
    v_mfma_f32_16x16x32_bf16 v[232:235], v[72:75], v[56:59], v[232:235]
    ds_read_b64_tr_b16 v[92:93], v9 offset:49152
    v_mfma_f32_16x16x32_bf16 v[236:239], v[76:79], v[56:59], v[236:239]
    ds_read_b64_tr_b16 v[94:95], v9 offset:51200
    buffer_load_dwordx4 v[56:59], v1, s[24:27], s72 offen offset:1024 sc1
    s_waitcnt vmcnt(11)
    v_mfma_f32_16x16x32_bf16 v[240:243], v[64:67], v[60:63], v[240:243]
    v_mfma_f32_16x16x32_bf16 v[244:247], v[68:71], v[60:63], v[244:247]
    v_mfma_f32_16x16x32_bf16 v[248:251], v[72:75], v[60:63], v[248:251]
    v_mfma_f32_16x16x32_bf16 v[252:255], v[76:79], v[60:63], v[252:255]
    buffer_load_dwordx4 v[60:63], v1, s[24:27], s73 offen offset:1024 sc1
    s_waitcnt lgkmcnt(0)
    s_waitcnt vmcnt(11)
    v_mfma_f32_16x16x32_bf16 v[192:195], v[80:83], v[32:35], v[192:195]
    v_mfma_f32_16x16x32_bf16 v[196:199], v[84:87], v[32:35], v[196:199]
    v_mfma_f32_16x16x32_bf16 v[200:203], v[88:91], v[32:35], v[200:203]
    v_mfma_f32_16x16x32_bf16 v[204:207], v[92:95], v[32:35], v[204:207]
    buffer_load_dwordx4 v[32:35], v1, s[24:27], s72 offen offset:2048 sc1
    s_waitcnt vmcnt(11)
    v_mfma_f32_16x16x32_bf16 v[208:211], v[80:83], v[36:39], v[208:211]
    ds_read_b64_tr_b16 v[96:97], v10 offset:0
    v_mfma_f32_16x16x32_bf16 v[212:215], v[84:87], v[36:39], v[212:215]
    ds_read_b64_tr_b16 v[98:99], v10 offset:2048
    v_mfma_f32_16x16x32_bf16 v[216:219], v[88:91], v[36:39], v[216:219]
    ds_read_b64_tr_b16 v[100:101], v11 offset:0
    v_mfma_f32_16x16x32_bf16 v[220:223], v[92:95], v[36:39], v[220:223]
    ds_read_b64_tr_b16 v[102:103], v11 offset:2048
    buffer_load_dwordx4 v[36:39], v1, s[24:27], s73 offen offset:2048 sc1
    s_waitcnt vmcnt(11)
    v_mfma_f32_16x16x32_bf16 v[224:227], v[80:83], v[40:43], v[224:227]
    ds_read_b64_tr_b16 v[104:105], v12 offset:0
    v_mfma_f32_16x16x32_bf16 v[228:231], v[84:87], v[40:43], v[228:231]
    ds_read_b64_tr_b16 v[106:107], v12 offset:2048
    v_mfma_f32_16x16x32_bf16 v[232:235], v[88:91], v[40:43], v[232:235]
    ds_read_b64_tr_b16 v[108:109], v13 offset:0
    v_mfma_f32_16x16x32_bf16 v[236:239], v[92:95], v[40:43], v[236:239]
    ds_read_b64_tr_b16 v[110:111], v13 offset:2048
    buffer_load_dwordx4 v[40:43], v1, s[24:27], s72 offen offset:3072 sc1
    s_waitcnt vmcnt(11)
    v_mfma_f32_16x16x32_bf16 v[240:243], v[80:83], v[44:47], v[240:243]
    v_mfma_f32_16x16x32_bf16 v[244:247], v[84:87], v[44:47], v[244:247]
    v_mfma_f32_16x16x32_bf16 v[248:251], v[88:91], v[44:47], v[248:251]
    v_mfma_f32_16x16x32_bf16 v[252:255], v[92:95], v[44:47], v[252:255]
    buffer_load_dwordx4 v[44:47], v1, s[24:27], s73 offen offset:3072 sc1
    s_waitcnt lgkmcnt(0)
    s_waitcnt vmcnt(11)
    v_mfma_f32_16x16x32_bf16 v[192:195], v[96:99], v[16:19], v[192:195]
    v_mfma_f32_16x16x32_bf16 v[196:199], v[100:103], v[16:19], v[196:199]
    v_mfma_f32_16x16x32_bf16 v[200:203], v[104:107], v[16:19], v[200:203]
    v_mfma_f32_16x16x32_bf16 v[204:207], v[108:111], v[16:19], v[204:207]
    s_waitcnt vmcnt(10)
    v_mfma_f32_16x16x32_bf16 v[208:211], v[96:99], v[20:23], v[208:211]
    ds_read_b64_tr_b16 v[112:113], v6 offset:16384
    ds_read_b64_tr_b16 v[128:129], v6 offset:0
    v_mfma_f32_16x16x32_bf16 v[212:215], v[100:103], v[20:23], v[212:215]
    ds_read_b64_tr_b16 v[114:115], v6 offset:18432
    ds_read_b64_tr_b16 v[130:131], v6 offset:2048
    v_mfma_f32_16x16x32_bf16 v[216:219], v[104:107], v[20:23], v[216:219]
    ds_read_b64_tr_b16 v[116:117], v7 offset:16384
    ds_read_b64_tr_b16 v[132:133], v7 offset:0
    v_mfma_f32_16x16x32_bf16 v[220:223], v[108:111], v[20:23], v[220:223]
    ds_read_b64_tr_b16 v[118:119], v7 offset:18432
    ds_read_b64_tr_b16 v[134:135], v7 offset:2048
    s_waitcnt vmcnt(9)
    v_mfma_f32_16x16x32_bf16 v[224:227], v[96:99], v[24:27], v[224:227]
    ds_read_b64_tr_b16 v[120:121], v8 offset:16384
    ds_read_b64_tr_b16 v[136:137], v8 offset:0
    v_mfma_f32_16x16x32_bf16 v[228:231], v[100:103], v[24:27], v[228:231]
    ds_read_b64_tr_b16 v[122:123], v8 offset:18432
    ds_read_b64_tr_b16 v[138:139], v8 offset:2048
    v_mfma_f32_16x16x32_bf16 v[232:235], v[104:107], v[24:27], v[232:235]
    ds_read_b64_tr_b16 v[124:125], v9 offset:16384
    ds_read_b64_tr_b16 v[140:141], v9 offset:0
    v_mfma_f32_16x16x32_bf16 v[236:239], v[108:111], v[24:27], v[236:239]
    ds_read_b64_tr_b16 v[126:127], v9 offset:18432
    ds_read_b64_tr_b16 v[142:143], v9 offset:2048
    s_waitcnt vmcnt(8)
    v_mfma_f32_16x16x32_bf16 v[240:243], v[96:99], v[28:31], v[240:243]
    v_mfma_f32_16x16x32_bf16 v[244:247], v[100:103], v[28:31], v[244:247]
    v_mfma_f32_16x16x32_bf16 v[248:251], v[104:107], v[28:31], v[248:251]
    v_mfma_f32_16x16x32_bf16 v[252:255], v[108:111], v[28:31], v[252:255]
    s_waitcnt lgkmcnt(0)
    s_cmp_lt_u32 s3, 4
    s_cbranch_scc1 L_NB
    s_barrier
L_NB:
    v_and_b32 v2, 15, v0
    v_lshrrev_b32 v3, 4, v0
    v_lshrrev_b32 v4, 1, v3
    v_lshl_add_u32 v2, v4, 2, v2
    v_and_b32 v2, 15, v2
    v_lshlrev_b32 v2, 4, v2
    v_lshl_add_u32 v2, v3, 8, v2
    v_add_u32 v2, s74, v2
    v_xor_b32 v3, 0x80, v2
    s_waitcnt vmcnt(7)
    v_mfma_f32_16x16x32_bf16 v[192:195], v[112:115], v[48:51], v[192:195]
    v_mfma_f32_16x16x32_bf16 v[196:199], v[116:119], v[48:51], v[196:199]
    v_mfma_f32_16x16x32_bf16 v[200:203], v[120:123], v[48:51], v[200:203]
    v_mfma_f32_16x16x32_bf16 v[204:207], v[124:127], v[48:51], v[204:207]
    s_waitcnt vmcnt(6)
    v_mfma_f32_16x16x32_bf16 v[192:195], v[128:131], v[52:55], v[192:195]
    v_mfma_f32_16x16x32_bf16 v[196:199], v[132:135], v[52:55], v[196:199]
    v_mfma_f32_16x16x32_bf16 v[200:203], v[136:139], v[52:55], v[200:203]
    v_mfma_f32_16x16x32_bf16 v[204:207], v[140:143], v[52:55], v[204:207]
    s_waitcnt vmcnt(5)
    v_mfma_f32_16x16x32_bf16 v[208:211], v[112:115], v[56:59], v[208:211]
    v_mfma_f32_16x16x32_bf16 v[212:215], v[116:119], v[56:59], v[212:215]
    v_mfma_f32_16x16x32_bf16 v[216:219], v[120:123], v[56:59], v[216:219]
    v_mfma_f32_16x16x32_bf16 v[220:223], v[124:127], v[56:59], v[220:223]
    ds_write_b128 v2, v[192:195] offset:0
    ds_write_b128 v3, v[196:199] offset:1024
    ds_write_b128 v2, v[200:203] offset:2048
    ds_write_b128 v3, v[204:207] offset:3072
    s_waitcnt vmcnt(4)
    v_mfma_f32_16x16x32_bf16 v[208:211], v[128:131], v[60:63], v[208:211]
    v_mfma_f32_16x16x32_bf16 v[212:215], v[132:135], v[60:63], v[212:215]
    v_mfma_f32_16x16x32_bf16 v[216:219], v[136:139], v[60:63], v[216:219]
    v_mfma_f32_16x16x32_bf16 v[220:223], v[140:143], v[60:63], v[220:223]
    s_waitcnt vmcnt(3)
    v_mfma_f32_16x16x32_bf16 v[224:227], v[112:115], v[32:35], v[224:227]
    v_mfma_f32_16x16x32_bf16 v[228:231], v[116:119], v[32:35], v[228:231]
    v_mfma_f32_16x16x32_bf16 v[232:235], v[120:123], v[32:35], v[232:235]
    v_mfma_f32_16x16x32_bf16 v[236:239], v[124:127], v[32:35], v[236:239]
    ds_write_b128 v2, v[208:211] offset:16384
    ds_write_b128 v3, v[212:215] offset:17408
    ds_write_b128 v2, v[216:219] offset:18432
    ds_write_b128 v3, v[220:223] offset:19456
    s_waitcnt vmcnt(2)
    v_mfma_f32_16x16x32_bf16 v[224:227], v[128:131], v[36:39], v[224:227]
    v_mfma_f32_16x16x32_bf16 v[228:231], v[132:135], v[36:39], v[228:231]
    v_mfma_f32_16x16x32_bf16 v[232:235], v[136:139], v[36:39], v[232:235]
    v_mfma_f32_16x16x32_bf16 v[236:239], v[140:143], v[36:39], v[236:239]
    s_waitcnt vmcnt(1)
    v_mfma_f32_16x16x32_bf16 v[240:243], v[112:115], v[40:43], v[240:243]
    v_mfma_f32_16x16x32_bf16 v[244:247], v[116:119], v[40:43], v[244:247]
    v_mfma_f32_16x16x32_bf16 v[248:251], v[120:123], v[40:43], v[248:251]
    v_mfma_f32_16x16x32_bf16 v[252:255], v[124:127], v[40:43], v[252:255]
    ds_write_b128 v2, v[224:227] offset:32768
    ds_write_b128 v3, v[228:231] offset:33792
    ds_write_b128 v2, v[232:235] offset:34816
    ds_write_b128 v3, v[236:239] offset:35840
    s_waitcnt vmcnt(0)
    v_mfma_f32_16x16x32_bf16 v[240:243], v[128:131], v[44:47], v[240:243]
    v_mfma_f32_16x16x32_bf16 v[244:247], v[132:135], v[44:47], v[244:247]
    v_mfma_f32_16x16x32_bf16 v[248:251], v[136:139], v[44:47], v[248:251]
    v_mfma_f32_16x16x32_bf16 v[252:255], v[140:143], v[44:47], v[252:255]
    s_nop 7
    ds_write_b128 v2, v[240:243] offset:49152
    ds_write_b128 v3, v[244:247] offset:50176
    ds_write_b128 v2, v[248:251] offset:51200
    ds_write_b128 v3, v[252:255] offset:52224
    s_waitcnt lgkmcnt(0)
    s_barrier
    s_cmp_lt_u32 s3, 4
    s_cbranch_scc0 L_FIN
    v_lshrrev_b32 v18, 3, v0
    v_and_b32 v19, 7, v0
    v_and_b32 v20, 3, v19
    v_lshl_add_u32 v20, v20, 2, v18
    v_and_b32 v20, 15, v20
    v_lshlrev_b32 v20, 4, v20
    v_lshl_add_u32 v20, v19, 9, v20
    s_lshl_b32 s34, s3, 14
    v_add_u32 v20, s34, v20
    v_xor_b32 v21, 0x80, v20
    ds_read_b128 v[32:35], v20 offset:0
    ds_read_b128 v[36:39], v20 offset:256
    ds_read_b128 v[40:43], v21 offset:0
    ds_read_b128 v[44:47], v21 offset:256
    ds_read_b128 v[48:51], v20 offset:4096
    ds_read_b128 v[52:55], v20 offset:4352
    ds_read_b128 v[56:59], v21 offset:4096
    ds_read_b128 v[60:63], v21 offset:4352
    ds_read_b128 v[64:67], v20 offset:8192
    ds_read_b128 v[68:71], v20 offset:8448
    ds_read_b128 v[72:75], v21 offset:8192
    ds_read_b128 v[76:79], v21 offset:8448
    ds_read_b128 v[80:83], v20 offset:12288
    ds_read_b128 v[84:87], v20 offset:12544
    ds_read_b128 v[88:91], v21 offset:12288
    ds_read_b128 v[92:95], v21 offset:12544
    v_lshlrev_b32 v19, 4, v19
    v_lshl_add_u32 v18, v18, 11, v19
    s_lshl_b32 s34, s50, 2
    s_add_u32 s34, s34, s3
    s_lshl_b32 s34, s34, 15
    s_lshl_b32 s35, s51, 7
    s_add_u32 s34, s34, s35
    s_add_u32 s35, s34, 16384
    s_waitcnt lgkmcnt(8)
    v_pk_add_f32 v[32:33], v[32:33], v[48:49]
    v_pk_add_f32 v[34:35], v[34:35], v[50:51]
    v_pk_add_f32 v[36:37], v[36:37], v[52:53]
    v_pk_add_f32 v[38:39], v[38:39], v[54:55]
    v_pk_add_f32 v[40:41], v[40:41], v[56:57]
    v_pk_add_f32 v[42:43], v[42:43], v[58:59]
    v_pk_add_f32 v[44:45], v[44:45], v[60:61]
    v_pk_add_f32 v[46:47], v[46:47], v[62:63]
    s_waitcnt lgkmcnt(4)
    v_pk_add_f32 v[32:33], v[32:33], v[64:65]
    v_pk_add_f32 v[34:35], v[34:35], v[66:67]
    v_pk_add_f32 v[36:37], v[36:37], v[68:69]
    v_pk_add_f32 v[38:39], v[38:39], v[70:71]
    v_pk_add_f32 v[40:41], v[40:41], v[72:73]
    v_pk_add_f32 v[42:43], v[42:43], v[74:75]
    v_pk_add_f32 v[44:45], v[44:45], v[76:77]
    v_pk_add_f32 v[46:47], v[46:47], v[78:79]
    s_waitcnt lgkmcnt(0)
    v_pk_add_f32 v[32:33], v[32:33], v[80:81]
    v_pk_add_f32 v[34:35], v[34:35], v[82:83]
    v_pk_add_f32 v[36:37], v[36:37], v[84:85]
    v_pk_add_f32 v[38:39], v[38:39], v[86:87]
    v_pk_add_f32 v[40:41], v[40:41], v[88:89]
    v_pk_add_f32 v[42:43], v[42:43], v[90:91]
    v_pk_add_f32 v[44:45], v[44:45], v[92:93]
    v_pk_add_f32 v[46:47], v[46:47], v[94:95]
    v_add_u32 v20, 81920, v20
    v_add_u32 v21, 81920, v21
    s_barrier
    ds_read_b128 v[48:51], v20 offset:0
    ds_read_b128 v[52:55], v20 offset:256
    ds_read_b128 v[56:59], v21 offset:0
    ds_read_b128 v[60:63], v21 offset:256
    ds_read_b128 v[64:67], v20 offset:4096
    ds_read_b128 v[68:71], v20 offset:4352
    ds_read_b128 v[72:75], v21 offset:4096
    ds_read_b128 v[76:79], v21 offset:4352
    ds_read_b128 v[80:83], v20 offset:8192
    ds_read_b128 v[84:87], v20 offset:8448
    ds_read_b128 v[88:91], v21 offset:8192
    ds_read_b128 v[92:95], v21 offset:8448
    ds_read_b128 v[96:99], v20 offset:12288
    ds_read_b128 v[100:103], v20 offset:12544
    ds_read_b128 v[104:107], v21 offset:12288
    ds_read_b128 v[108:111], v21 offset:12544
    s_waitcnt lgkmcnt(12)
    v_pk_add_f32 v[32:33], v[32:33], v[48:49]
    v_pk_add_f32 v[34:35], v[34:35], v[50:51]
    v_pk_add_f32 v[36:37], v[36:37], v[52:53]
    v_pk_add_f32 v[38:39], v[38:39], v[54:55]
    v_pk_add_f32 v[40:41], v[40:41], v[56:57]
    v_pk_add_f32 v[42:43], v[42:43], v[58:59]
    v_pk_add_f32 v[44:45], v[44:45], v[60:61]
    v_pk_add_f32 v[46:47], v[46:47], v[62:63]
    s_waitcnt lgkmcnt(8)
    v_pk_add_f32 v[32:33], v[32:33], v[64:65]
    v_pk_add_f32 v[34:35], v[34:35], v[66:67]
    v_pk_add_f32 v[36:37], v[36:37], v[68:69]
    v_pk_add_f32 v[38:39], v[38:39], v[70:71]
    v_pk_add_f32 v[40:41], v[40:41], v[72:73]
    v_pk_add_f32 v[42:43], v[42:43], v[74:75]
    v_pk_add_f32 v[44:45], v[44:45], v[76:77]
    v_pk_add_f32 v[46:47], v[46:47], v[78:79]
    s_waitcnt lgkmcnt(4)
    v_pk_add_f32 v[32:33], v[32:33], v[80:81]
    v_pk_add_f32 v[34:35], v[34:35], v[82:83]
    v_pk_add_f32 v[36:37], v[36:37], v[84:85]
    v_pk_add_f32 v[38:39], v[38:39], v[86:87]
    v_pk_add_f32 v[40:41], v[40:41], v[88:89]
    v_pk_add_f32 v[42:43], v[42:43], v[90:91]
    v_pk_add_f32 v[44:45], v[44:45], v[92:93]
    v_pk_add_f32 v[46:47], v[46:47], v[94:95]
    s_waitcnt lgkmcnt(0)
    v_pk_add_f32 v[32:33], v[32:33], v[96:97]
    v_pk_add_f32 v[34:35], v[34:35], v[98:99]
    v_pk_add_f32 v[36:37], v[36:37], v[100:101]
    v_pk_add_f32 v[38:39], v[38:39], v[102:103]
    v_pk_add_f32 v[40:41], v[40:41], v[104:105]
    v_pk_add_f32 v[42:43], v[42:43], v[106:107]
    v_pk_add_f32 v[44:45], v[44:45], v[108:109]
    v_pk_add_f32 v[46:47], v[46:47], v[110:111]
    v_cvt_pk_bf16_f32 v24, v32, v33
    v_cvt_pk_bf16_f32 v25, v34, v35
    v_cvt_pk_bf16_f32 v26, v36, v37
    v_cvt_pk_bf16_f32 v27, v38, v39
    buffer_store_dwordx4 v[24:27], v18, s[56:59], s34 offen sc0 sc1
    v_cvt_pk_bf16_f32 v28, v40, v41
    v_cvt_pk_bf16_f32 v29, v42, v43
    v_cvt_pk_bf16_f32 v30, v44, v45
    v_cvt_pk_bf16_f32 v31, v46, v47
    buffer_store_dwordx4 v[28:31], v18, s[56:59], s35 offen sc0 sc1
L_FIN:
L_END:
    s_endpgm
    .section .rodata,"a"
    .p2align 6
    .amdhsa_kernel standalone__geglu_ffn__sampling_kernel
    .amdhsa_next_free_vgpr 256
    .amdhsa_next_free_sgpr 102
    .amdhsa_accum_offset 256
    .amdhsa_group_segment_fixed_size 0
    .amdhsa_kernarg_size 56
    .amdhsa_user_sgpr_count 2
    .amdhsa_user_sgpr_kernarg_segment_ptr 1
    .amdhsa_system_sgpr_workgroup_id_x 1
    .end_amdhsa_kernel
```
